```python
import torch

def _softmax(x, axis=-1):
    return torch.softmax(x, dim=axis)
def _gelu(x):
    return torch.nn.functional.gelu(x, approximate="tanh")
def _silu(x):
    return torch.nn.functional.silu(x)
def _sigmoid(x):
    return torch.sigmoid(x)
def _layernorm(x, axis=-1, eps=1e-5):
    m = x.mean(dim=axis, keepdim=True)
    v = x.var(dim=axis, keepdim=True, unbiased=False)
    return (x - m) / torch.sqrt(v + eps)
def _scatter_add(tgt, idx, src, axis=0):
    return tgt.clone().index_add_(axis, idx, src)
def _segment_sum(src, seg, n):
    out = torch.zeros((n,) + src.shape[1:], dtype=src.dtype)
    return out.index_add_(0, seg, src)
def _pad(x, pw):
    flat = tuple(v for pair in reversed(pw) for v in pair)
    return torch.nn.functional.pad(x, flat)

kernel_name = 'recurrent_scan__sliding_block_cached__glu_gated_geglu__decode'

def setup_inputs():

    _w = (lambda a: (lambda t: t.to(torch.bfloat16) if t.is_floating_point() else t)(torch.as_tensor(a)))
    def _A_setup():
        B, Sq, D = 2, 1, 512
        Hq, Hkv, Sk, Dh = 32, 32, 4096, 128
        assert Hq % Hkv == 0, (Hq, Hkv)
        return {
            "x": _w((lambda *s: torch.randn(*s, dtype=torch.bfloat16) * 0.2)(B, Sq, D)),
            "k_cache": _w((lambda *s: torch.randn(*s, dtype=torch.bfloat16) * 1.6)(B, Hkv, Sk, Dh)),
            "v_cache": _w((lambda *s: torch.randn(*s, dtype=torch.bfloat16) * 1.6)(B, Hkv, Sk, Dh)),
            "wq": _w((lambda *s: torch.randn(*s, dtype=torch.bfloat16) * 1.6)(D, Hq * Dh) * (D ** -0.5)),
            "wo": _w((lambda *s: torch.randn(*s, dtype=torch.bfloat16) * 1.6)(Hq * Dh, D) * ((Hq * Dh) ** -0.5)),
        }
    _A_in = _A_setup()

    def _B_setup():
        B, S, Dm, Df = 2, 1, 512, 1376
        return {
            "x": _w((lambda *s: torch.randn(*s, dtype=torch.bfloat16) * 0.2)(B, S, Dm)),
            "w_gate": _w((lambda *s: torch.randn(*s, dtype=torch.bfloat16) * 0.8)(Dm, Df) * (Dm ** -0.5)),
            "w_up": _w((lambda *s: torch.randn(*s, dtype=torch.bfloat16) * 0.8)(Dm, Df) * (Dm ** -0.5)),
            "w_down": _w((lambda *s: torch.randn(*s, dtype=torch.bfloat16) * 0.8)(Df, Dm) * (Df ** -0.5)),
        }
    _B_in = _B_setup()

    return {
        "A_x": _A_in["x"],
        "A_k_cache": _A_in["k_cache"],
        "A_v_cache": _A_in["v_cache"],
        "A_wq": _A_in["wq"],
        "A_wo": _A_in["wo"],
        "B_x": _B_in["x"],
        "B_w_gate": _B_in["w_gate"],
        "B_w_up": _B_in["w_up"],
        "B_w_down": _B_in["w_down"],
    }

def reference(A_x, A_k_cache, A_v_cache, A_wq, A_wo, B_x, B_w_gate, B_w_up, B_w_down):
    def _A_ref(x, k_cache, v_cache, wq, wo):
        B, Sq, D = x.shape
        Hq, Dh = 32, 128
        Hkv, Sk = k_cache.shape[1], k_cache.shape[2]
        W = min(4096, max(256, Sk // 4))
        rep = Hq // Hkv
        q = (lambda x, *d: x.permute(*d))((x @ wq).reshape(B, Sq, Hq, Dh), 0, 2, 1, 3)
        k = (lambda x, n, axis: torch.repeat_interleave(x, n, dim=axis))(k_cache[:, :, Sk - W:, :], rep, axis=1)
        v = (lambda x, n, axis: torch.repeat_interleave(x, n, dim=axis))(v_cache[:, :, Sk - W:, :], rep, axis=1)
        scores = torch.einsum("bhqd,bhkd->bhqk", q, k) * (Dh ** -0.5)
        p = _softmax(scores, axis=-1)
        o = torch.einsum("bhqk,bhkd->bhqd", p, v)
        return (lambda x, *d: x.permute(*d))(o, 0, 2, 1, 3).reshape(B, Sq, Hq * Dh) @ wo

    def _B_ref(x, w_gate, w_up, w_down):
        g = torch.einsum("bsd,df->bsf", x, w_gate)
        u = torch.einsum("bsd,df->bsf", x, w_up)
        h = _gelu(g) * u
        return torch.einsum("bsf,fd->bsd", h, w_down)

    x = A_x
    xn = _layernorm(x, axis=-1)
    s = _A_ref(xn, A_k_cache, A_v_cache, A_wq, A_wo)
    g = _silu(_B_ref(xn, B_w_gate, B_w_up, B_w_down))
    return x + s * g
```

```asm
; @launch grid=(256,1,1) block=(384,1,1) lds=7424
.amdgcn_target "amdgcn-amd-amdhsa--gfx950"
.text
.globl recurrent_scan__sliding_block_cached__glu_gated_geglu__decode_kernel
.p2align 8
.type recurrent_scan__sliding_block_cached__glu_gated_geglu__decode_kernel,@function
recurrent_scan__sliding_block_cached__glu_gated_geglu__decode_kernel:
    s_load_dwordx16 s[4:19], s[0:1], 0
    s_load_dwordx8 s[20:27], s[0:1], 64
    v_lshrrev_b32 v1, 6, v0
    v_and_b32 v0, 63, v0
    v_readfirstlane_b32 s28, v1
    s_cmpk_ge_u32 s2, 256
    s_cbranch_scc1 L_end
    s_and_b32 s29, s2, 7
    s_lshr_b32 s30, s2, 3
    s_and_b32 s33, s30, 3
    s_lshl2_add_u32 s31, s29, s33
    s_lshr_b32 s32, s2, 5
    v_lshrrev_b32 v1, 4, v0
    s_getpc_b64 s[34:35]
    s_lshl2_add_u32 s53, s30, s28
    s_lshl_b32 s53, s53, 7
    v_mov_b32 v31, s53
    global_load_dword v31, v31, s[34:35]
    s_cmp_lt_u32 s28, 2
    s_cbranch_scc1 L_As
L_Ss:
    s_lshr_b32 s50, s32, 2
    s_and_b32 s51, s32, 3
    s_lshl_b32 s33, s50, 5
    s_add_u32 s33, s33, s31
    s_lshl4_add_u32 s33, s33, s51
    s_lshl_b32 s33, s33, 16
    s_mul_i32 s34, s28, 0x5000
    s_add_u32 s33, s33, s34
    s_add_u32 s33, s33, 0xB6000
    v_bfe_u32 v14, v0, 2, 2
    v_lshlrev_b32 v4, 8, v14
    v_lshl_add_u32 v4, v1, 6, v4
    v_and_b32 v5, 3, v0
    v_lshl_add_u32 v4, v5, 4, v4
    s_waitcnt lgkmcnt(0)
    s_add_u32 s54, s6, s33
    s_addc_u32 s55, s7, 0
    global_load_dwordx4 v[32:35], v4, s[54:55] offset:0 nt
    global_load_dwordx4 v[36:39], v4, s[54:55] offset:1024 nt
    s_branch L_S2
L_As:
    v_and_b32 v3, 4, v0
    v_mul_u32_u24 v4, 240, v3
    v_lshl_add_u32 v4, v0, 4, v4
    v_lshl_add_u32 v5, s32, 2, v1
    v_lshl_add_u32 v5, v3, 3, v5
    v_lshlrev_b32 v5, 5, v5
    s_movk_i32 s50, 8192
    s_lshl_b32 s52, s31, 8
    s_mov_b32 s56, 16
    s_lshl_b32 s42, 1, 22
    s_cmp_eq_u32 s28, 0
    s_cbranch_scc1 L_Ap
    s_mul_i32 s52, s29, 43
    s_add_u32 s52, s52, 4
    s_add_u32 s56, s52, 43
    s_lshr_b32 s52, s52, 3
    s_lshr_b32 s56, s56, 3
    s_and_b32 s55, s33, 1
    s_add_u32 s55, s55, 3
    s_cmp_lt_u32 s33, 2
    s_cselect_b32 s54, s55, 0
    s_add_u32 s52, s52, s54
    s_sub_u32 s56, s56, s52
    s_min_u32 s56, s56, s55
    s_lshl_b32 s56, s56, 2
    s_lshl_b32 s52, s52, 6
    s_movk_i32 s50, 2752
    s_lshl_b32 s42, s50, 9
L_Ap:
    v_and_b32 v2, 15, v0
    s_lshl_b32 s51, s32, 6
    s_lshl_b32 s34, s50, 4
    v_mul_u32_u24 v6, s34, v1
    v_cmp_gt_u32 vcc, s56, v2
    s_mul_i32 s57, s51, s50
    v_lshl_add_u32 v6, v2, 4, v6
    s_add_u32 s57, s57, s52
    s_lshl_b32 s43, 1, 17
    s_bitcmp0_b32 s30, 0
    s_waitcnt lgkmcnt(0)
    s_cselect_b64 s[40:41], s[18:19], s[16:17]
    global_load_dwordx4 v[8:11], v4, s[4:5]
    global_load_dwordx4 v[12:15], v4, s[4:5] offset:64
    global_load_dwordx4 v[16:19], v5, s[4:5]
    global_load_dwordx4 v[20:23], v5, s[4:5] offset:16
    s_cmp_eq_u32 s28, 0
    s_cselect_b64 s[40:41], s[10:11], s[40:41]
    s_mov_b64 exec, vcc
    s_cbranch_scc0 L_A1s
    buffer_load_dwordx4 v[64:67], v6, s[40:43], s57 offen nt
    s_add_u32 s57, s57, s50
    buffer_load_dwordx4 v[68:71], v6, s[40:43], s57 offen nt
    s_add_u32 s57, s57, s50
    buffer_load_dwordx4 v[72:75], v6, s[40:43], s57 offen nt
    s_add_u32 s57, s57, s50
    buffer_load_dwordx4 v[76:79], v6, s[40:43], s57 offen nt
    s_add_u32 s57, s57, s50
    buffer_load_dwordx4 v[80:83], v6, s[40:43], s57 offen nt
    s_add_u32 s57, s57, s50
    buffer_load_dwordx4 v[84:87], v6, s[40:43], s57 offen nt
    s_add_u32 s57, s57, s50
    buffer_load_dwordx4 v[88:91], v6, s[40:43], s57 offen nt
    s_add_u32 s57, s57, s50
    buffer_load_dwordx4 v[92:95], v6, s[40:43], s57 offen nt
    s_add_u32 s57, s57, s50
    buffer_load_dwordx4 v[96:99], v6, s[40:43], s57 offen nt
    s_add_u32 s57, s57, s50
    buffer_load_dwordx4 v[100:103], v6, s[40:43], s57 offen nt
    s_add_u32 s57, s57, s50
    buffer_load_dwordx4 v[104:107], v6, s[40:43], s57 offen nt
    s_add_u32 s57, s57, s50
    buffer_load_dwordx4 v[108:111], v6, s[40:43], s57 offen nt
    s_add_u32 s57, s57, s50
    buffer_load_dwordx4 v[112:115], v6, s[40:43], s57 offen nt
    s_add_u32 s57, s57, s50
    buffer_load_dwordx4 v[116:119], v6, s[40:43], s57 offen nt
    s_add_u32 s57, s57, s50
    buffer_load_dwordx4 v[120:123], v6, s[40:43], s57 offen nt
    s_add_u32 s57, s57, s50
    buffer_load_dwordx4 v[124:127], v6, s[40:43], s57 offen nt
    s_branch L_ldd
L_A1s:
    buffer_load_dwordx4 v[64:67], v6, s[40:43], s57 offen
    s_add_u32 s57, s57, s50
    buffer_load_dwordx4 v[68:71], v6, s[40:43], s57 offen
    s_add_u32 s57, s57, s50
    buffer_load_dwordx4 v[72:75], v6, s[40:43], s57 offen
    s_add_u32 s57, s57, s50
    buffer_load_dwordx4 v[76:79], v6, s[40:43], s57 offen
    s_add_u32 s57, s57, s50
    buffer_load_dwordx4 v[80:83], v6, s[40:43], s57 offen
    s_add_u32 s57, s57, s50
    buffer_load_dwordx4 v[84:87], v6, s[40:43], s57 offen
    s_add_u32 s57, s57, s50
    buffer_load_dwordx4 v[88:91], v6, s[40:43], s57 offen
    s_add_u32 s57, s57, s50
    buffer_load_dwordx4 v[92:95], v6, s[40:43], s57 offen
    s_add_u32 s57, s57, s50
    buffer_load_dwordx4 v[96:99], v6, s[40:43], s57 offen
    s_add_u32 s57, s57, s50
    buffer_load_dwordx4 v[100:103], v6, s[40:43], s57 offen
    s_add_u32 s57, s57, s50
    buffer_load_dwordx4 v[104:107], v6, s[40:43], s57 offen
    s_add_u32 s57, s57, s50
    buffer_load_dwordx4 v[108:111], v6, s[40:43], s57 offen
    s_add_u32 s57, s57, s50
    buffer_load_dwordx4 v[112:115], v6, s[40:43], s57 offen
    s_add_u32 s57, s57, s50
    buffer_load_dwordx4 v[116:119], v6, s[40:43], s57 offen
    s_add_u32 s57, s57, s50
    buffer_load_dwordx4 v[120:123], v6, s[40:43], s57 offen
    s_add_u32 s57, s57, s50
    buffer_load_dwordx4 v[124:127], v6, s[40:43], s57 offen
L_ldd:
    s_mov_b64 s[66:67], vcc
    s_mov_b64 exec, -1
    s_load_dwordx2 s[44:45], s[26:27], 0
    s_barrier
    s_branch L_An
L_S2:
    v_mov_b32 v7, 0
    v_lshlrev_b32 v6, 2, v0
    ds_write_b32 v6, v7 offset:256
    s_waitcnt lgkmcnt(0)
    s_load_dwordx2 s[44:45], s[26:27], 0
    s_sub_u32 s28, s28, 2
    s_xor_b32 s56, s33, 4096
    s_xor_b32 s58, s33, 8192
    s_xor_b32 s60, s33, 12288
    v_and_b32 v2, 15, v0
    v_bfe_u32 v3, v0, 2, 1
    s_lshl_b32 s38, 1, 28
    s_lshl_b32 s39, 1, 17
    s_add_u32 s56, s6, s56
    s_addc_u32 s57, s7, 0
    s_add_u32 s58, s6, s58
    s_addc_u32 s59, s7, 0
    s_add_u32 s60, s6, s60
    s_addc_u32 s61, s7, 0
    s_setprio 1
    s_barrier
    global_load_dwordx4 v[40:43], v4, s[54:55] offset:2048 nt
    global_load_dwordx4 v[44:47], v4, s[54:55] offset:3072 nt
    s_waitcnt vmcnt(3)
    global_load_dwordx4 v[48:51], v4, s[56:57] offset:0 nt
    s_waitcnt vmcnt(3)
    global_load_dwordx4 v[52:55], v4, s[56:57] offset:1024 nt
    s_branch L_S
L_An:
    v_lshrrev_b32 v3, 2, v3
    s_lshl_b32 s38, 1, 28
    s_lshl_b32 s39, 1, 17
    s_mov_b32 s36, s26
    s_mov_b32 s37, s27
    s_xor_b32 s33, s33, 3
    s_lshl3_add_u32 s65, s33, s32
    s_and_b32 s33, s65, 15
    s_lshl4_add_u32 s33, s29, s33
    s_mul_i32 s33, s33, 12
    s_add_u32 s33, s33, s54
    s_lshl_b32 s53, s33, 7
    s_add_u32 s53, s53, 294912
    s_lshl4_add_u32 s33, s31, s32
    s_lshl_b32 s33, s33, 9
    s_add_u32 s33, s33, 4096
    s_cmp_eq_u32 s28, 0
    s_cselect_b32 s53, s33, s53
    s_movk_i32 s54, 768
    s_cmovk_i32 s54, 4096
    v_and_b32 v30, 1, v1
    v_mul_u32_u24 v30, s54, v30
    v_lshl_add_u32 v30, v2, 5, v30
    v_lshrrev_b32 v7, 5, v0
    v_lshl_add_u32 v30, v7, 4, v30
L_nob:
    s_setprio 0
    v_and_b32 v4, 1, v0
    v_lshlrev_b32 v4, 4, v4
    v_mov_b32 v5, 0xffff
    v_lshlrev_b32 v4, v4, v5
    v_and_b32 v5, 10, v0
    v_cmp_eq_u32 s[88:89], 0, v5
    v_cmp_eq_u32 s[90:91], 2, v5
    v_cmp_eq_u32 s[92:93], 8, v5
    v_cmp_eq_u32 s[94:95], 10, v5
    v_cndmask_b32 v24, 0, v4, s[88:89]
    v_cndmask_b32 v25, 0, v4, s[90:91]
    v_cndmask_b32 v26, 0, v4, s[92:93]
    v_cndmask_b32 v27, 0, v4, s[94:95]
    v_mov_b32 v7, 0x3ff
    s_getreg_b32 s64, hwreg(HW_REG_XCC_ID, 0, 4)
    s_waitcnt lgkmcnt(0)
    s_add_u32 s44, s44, 0x00100401
    s_add_u32 s45, s45, 1
    s_and_b32 s46, s44, 0x3ff
    s_bfe_u32 s47, s44, 0xa000a
    s_bfe_u32 s48, s44, 0xa0014
    s_and_b32 s49, s45, 0x3ff
    s_cmp_eq_u32 s28, 0
    s_cselect_b32 s64, s64, 0
    s_xor_b32 s64, s64, s49
    s_lshl_b32 s33, s28, 2
    s_sub_u32 s33, 264, s33
    v_mov_b32 v4, s33
    ds_write_b32 v4, v7
    s_waitcnt vmcnt(18)
    v_lshlrev_b32 v32, 16, v8
    v_and_b32 v33, 0xffff0000, v8
    v_lshlrev_b32 v34, 16, v9
    v_and_b32 v35, 0xffff0000, v9
    v_lshlrev_b32 v36, 16, v10
    v_and_b32 v37, 0xffff0000, v10
    v_lshlrev_b32 v38, 16, v11
    v_and_b32 v39, 0xffff0000, v11
    v_lshlrev_b32 v40, 16, v12
    v_and_b32 v41, 0xffff0000, v12
    v_lshlrev_b32 v42, 16, v13
    v_and_b32 v43, 0xffff0000, v13
    v_lshlrev_b32 v44, 16, v14
    v_and_b32 v45, 0xffff0000, v14
    v_lshlrev_b32 v46, 16, v15
    v_and_b32 v47, 0xffff0000, v15
    v_pk_add_f32 v[48:49], v[32:33], v[34:35]
    v_pk_add_f32 v[50:51], v[36:37], v[38:39]
    v_pk_add_f32 v[52:53], v[40:41], v[42:43]
    v_pk_add_f32 v[54:55], v[44:45], v[46:47]
    v_pk_add_f32 v[48:49], v[48:49], v[50:51]
    v_pk_add_f32 v[52:53], v[52:53], v[54:55]
    v_pk_add_f32 v[48:49], v[48:49], v[52:53]
    v_add_f32 v28, v48, v49
    s_nop 1
    v_add_f32_dpp v28, v28, v28 quad_perm:[1,0,3,2] row_mask:0xf bank_mask:0xf
    s_nop 1
    v_add_f32_dpp v28, v28, v28 quad_perm:[2,3,0,1] row_mask:0xf bank_mask:0xf
    s_nop 1
    v_add_f32_dpp v28, v28, v28 row_ror:8 row_mask:0xf bank_mask:0xf
    v_mov_b32 v29, v28
    s_nop 1
    v_permlane16_swap_b32 v28, v29
    v_add_f32 v28, v28, v29
    v_mov_b32 v29, v28
    s_nop 1
    v_permlane32_swap_b32 v28, v29
    v_add_f32 v28, v28, v29
    v_mul_f32 v28, 0xbb000000, v28
    v_mov_b32 v29, v28
    v_pk_add_f32 v[32:33], v[32:33], v[28:29]
    v_pk_add_f32 v[34:35], v[34:35], v[28:29]
    v_pk_add_f32 v[36:37], v[36:37], v[28:29]
    v_pk_add_f32 v[38:39], v[38:39], v[28:29]
    v_pk_add_f32 v[40:41], v[40:41], v[28:29]
    v_pk_add_f32 v[42:43], v[42:43], v[28:29]
    v_pk_add_f32 v[44:45], v[44:45], v[28:29]
    v_pk_add_f32 v[46:47], v[46:47], v[28:29]
    v_pk_mul_f32 v[48:49], v[32:33], v[32:33]
    v_pk_mul_f32 v[50:51], v[34:35], v[34:35]
    v_pk_fma_f32 v[48:49], v[36:37], v[36:37], v[48:49]
    v_pk_fma_f32 v[50:51], v[38:39], v[38:39], v[50:51]
    v_pk_fma_f32 v[48:49], v[40:41], v[40:41], v[48:49]
    v_pk_fma_f32 v[50:51], v[42:43], v[42:43], v[50:51]
    v_pk_fma_f32 v[48:49], v[44:45], v[44:45], v[48:49]
    v_pk_fma_f32 v[50:51], v[46:47], v[46:47], v[50:51]
    v_pk_add_f32 v[48:49], v[48:49], v[50:51]
    v_add_f32 v56, v48, v49
    s_waitcnt vmcnt(16)
    v_cvt_pk_bf16_f32 v28, v28, v28
    v_and_b32 v28, 0xffff0000, v28
    v_add_f32_dpp v56, v56, v56 quad_perm:[1,0,3,2] row_mask:0xf bank_mask:0xf
    v_lshlrev_b32 v32, 16, v16
    v_and_b32 v33, 0xffff0000, v16
    v_lshlrev_b32 v34, 16, v17
    v_and_b32 v35, 0xffff0000, v17
    v_add_f32_dpp v56, v56, v56 quad_perm:[2,3,0,1] row_mask:0xf bank_mask:0xf
    v_lshlrev_b32 v36, 16, v18
    v_and_b32 v37, 0xffff0000, v18
    v_lshlrev_b32 v38, 16, v19
    v_and_b32 v39, 0xffff0000, v19
    v_add_f32_dpp v56, v56, v56 row_ror:8 row_mask:0xf bank_mask:0xf
    v_mov_b32 v29, v28
    v_mov_b32 v57, v56
    v_lshlrev_b32 v40, 16, v20
    v_and_b32 v41, 0xffff0000, v20
    v_lshlrev_b32 v42, 16, v21
    v_and_b32 v43, 0xffff0000, v21
    v_permlane16_swap_b32 v56, v57
    v_add_f32 v56, v56, v57
    v_mov_b32 v57, v56
    v_lshlrev_b32 v44, 16, v22
    v_and_b32 v45, 0xffff0000, v22
    v_lshlrev_b32 v46, 16, v23
    v_and_b32 v47, 0xffff0000, v23
    v_permlane32_swap_b32 v56, v57
    v_add_f32 v56, v56, v57
    v_mul_f32 v56, 0x3b000000, v56
    v_cvt_pk_bf16_f32 v56, v56, v56
    v_and_b32 v56, 0xffff0000, v56
    v_add_f32 v56, 0x3727c5ac, v56
    v_cvt_pk_bf16_f32 v56, v56, v56
    v_and_b32 v56, 0xffff0000, v56
    v_sqrt_f32 v56, v56
    v_pk_add_f32 v[32:33], v[32:33], v[28:29]
    v_pk_add_f32 v[34:35], v[34:35], v[28:29]
    v_pk_add_f32 v[36:37], v[36:37], v[28:29]
    v_pk_add_f32 v[38:39], v[38:39], v[28:29]
    v_pk_add_f32 v[40:41], v[40:41], v[28:29]
    v_pk_add_f32 v[42:43], v[42:43], v[28:29]
    v_pk_add_f32 v[44:45], v[44:45], v[28:29]
    v_pk_add_f32 v[46:47], v[46:47], v[28:29]
    v_cvt_pk_bf16_f32 v56, v56, v56
    v_and_b32 v56, 0xffff0000, v56
    v_rcp_f32 v56, v56
    v_cvt_pk_bf16_f32 v16, v32, v33
    v_cvt_pk_bf16_f32 v17, v34, v35
    v_cvt_pk_bf16_f32 v18, v36, v37
    v_cvt_pk_bf16_f32 v19, v38, v39
    v_cvt_pk_bf16_f32 v20, v40, v41
    v_cvt_pk_bf16_f32 v21, v42, v43
    v_cvt_pk_bf16_f32 v22, v44, v45
    v_cvt_pk_bf16_f32 v23, v46, v47
    v_mov_b32 v57, v56
    v_lshlrev_b32 v32, 16, v16
    v_and_b32 v33, 0xffff0000, v16
    v_lshlrev_b32 v34, 16, v17
    v_and_b32 v35, 0xffff0000, v17
    v_lshlrev_b32 v36, 16, v18
    v_and_b32 v37, 0xffff0000, v18
    v_lshlrev_b32 v38, 16, v19
    v_and_b32 v39, 0xffff0000, v19
    v_lshlrev_b32 v40, 16, v20
    v_and_b32 v41, 0xffff0000, v20
    v_lshlrev_b32 v42, 16, v21
    v_and_b32 v43, 0xffff0000, v21
    v_lshlrev_b32 v44, 16, v22
    v_and_b32 v45, 0xffff0000, v22
    v_lshlrev_b32 v46, 16, v23
    v_and_b32 v47, 0xffff0000, v23
    v_pk_mul_f32 v[32:33], v[32:33], v[56:57]
    v_pk_mul_f32 v[34:35], v[34:35], v[56:57]
    v_pk_mul_f32 v[36:37], v[36:37], v[56:57]
    v_pk_mul_f32 v[38:39], v[38:39], v[56:57]
    v_pk_mul_f32 v[40:41], v[40:41], v[56:57]
    v_pk_mul_f32 v[42:43], v[42:43], v[56:57]
    v_pk_mul_f32 v[44:45], v[44:45], v[56:57]
    v_pk_mul_f32 v[46:47], v[46:47], v[56:57]
    v_cvt_pk_bf16_f32 v32, v32, v32
    v_cvt_pk_bf16_f32 v33, v33, v33
    v_cvt_pk_bf16_f32 v34, v34, v34
    v_cvt_pk_bf16_f32 v35, v35, v35
    v_cvt_pk_bf16_f32 v36, v36, v36
    v_cvt_pk_bf16_f32 v37, v37, v37
    v_cvt_pk_bf16_f32 v38, v38, v38
    v_cvt_pk_bf16_f32 v39, v39, v39
    v_cvt_pk_bf16_f32 v40, v40, v40
    v_cvt_pk_bf16_f32 v41, v41, v41
    v_cvt_pk_bf16_f32 v42, v42, v42
    v_cvt_pk_bf16_f32 v43, v43, v43
    v_cvt_pk_bf16_f32 v44, v44, v44
    v_cvt_pk_bf16_f32 v45, v45, v45
    v_cvt_pk_bf16_f32 v46, v46, v46
    v_cvt_pk_bf16_f32 v47, v47, v47
    v_and_b32 v48, v32, v24
    v_and_b32 v49, v32, v25
    v_and_b32 v50, v32, v26
    v_and_b32 v51, v32, v27
    s_waitcnt vmcnt(15)
    s_nop 0
    v_mfma_f32_16x16x32_bf16 v[128:131], v[48:51], v[64:67], 0
    v_and_b32 v52, v33, v24
    v_and_b32 v53, v33, v25
    v_and_b32 v54, v33, v26
    v_and_b32 v55, v33, v27
    s_waitcnt vmcnt(14)
    s_nop 0
    v_mfma_f32_16x16x32_bf16 v[128:131], v[52:55], v[68:71], v[128:131]
    v_and_b32 v56, v34, v24
    v_and_b32 v57, v34, v25
    v_and_b32 v58, v34, v26
    v_and_b32 v59, v34, v27
    s_waitcnt vmcnt(13)
    s_nop 0
    v_mfma_f32_16x16x32_bf16 v[128:131], v[56:59], v[72:75], v[128:131]
    v_and_b32 v60, v35, v24
    v_and_b32 v61, v35, v25
    v_and_b32 v62, v35, v26
    v_and_b32 v63, v35, v27
    s_waitcnt vmcnt(12)
    s_nop 0
    v_mfma_f32_16x16x32_bf16 v[128:131], v[60:63], v[76:79], v[128:131]
    v_and_b32 v48, v36, v24
    v_and_b32 v49, v36, v25
    v_and_b32 v50, v36, v26
    v_and_b32 v51, v36, v27
    s_waitcnt vmcnt(11)
    s_nop 0
    v_mfma_f32_16x16x32_bf16 v[128:131], v[48:51], v[80:83], v[128:131]
    v_and_b32 v52, v37, v24
    v_and_b32 v53, v37, v25
    v_and_b32 v54, v37, v26
    v_and_b32 v55, v37, v27
    s_waitcnt vmcnt(10)
    s_nop 0
    v_mfma_f32_16x16x32_bf16 v[128:131], v[52:55], v[84:87], v[128:131]
    v_and_b32 v56, v38, v24
    v_and_b32 v57, v38, v25
    v_and_b32 v58, v38, v26
    v_and_b32 v59, v38, v27
    s_waitcnt vmcnt(9)
    s_nop 0
    v_mfma_f32_16x16x32_bf16 v[128:131], v[56:59], v[88:91], v[128:131]
    v_and_b32 v60, v39, v24
    v_and_b32 v61, v39, v25
    v_and_b32 v62, v39, v26
    v_and_b32 v63, v39, v27
    s_waitcnt vmcnt(8)
    s_nop 0
    v_mfma_f32_16x16x32_bf16 v[128:131], v[60:63], v[92:95], v[128:131]
    v_and_b32 v48, v40, v24
    v_and_b32 v49, v40, v25
    v_and_b32 v50, v40, v26
    v_and_b32 v51, v40, v27
    s_waitcnt vmcnt(7)
    s_nop 0
    v_mfma_f32_16x16x32_bf16 v[128:131], v[48:51], v[96:99], v[128:131]
    v_and_b32 v52, v41, v24
    v_and_b32 v53, v41, v25
    v_and_b32 v54, v41, v26
    v_and_b32 v55, v41, v27
    s_waitcnt vmcnt(6)
    s_nop 0
    v_mfma_f32_16x16x32_bf16 v[128:131], v[52:55], v[100:103], v[128:131]
    v_and_b32 v56, v42, v24
    v_and_b32 v57, v42, v25
    v_and_b32 v58, v42, v26
    v_and_b32 v59, v42, v27
    s_waitcnt vmcnt(5)
    s_nop 0
    v_mfma_f32_16x16x32_bf16 v[128:131], v[56:59], v[104:107], v[128:131]
    v_and_b32 v60, v43, v24
    v_and_b32 v61, v43, v25
    v_and_b32 v62, v43, v26
    v_and_b32 v63, v43, v27
    s_waitcnt vmcnt(4)
    s_nop 0
    v_mfma_f32_16x16x32_bf16 v[128:131], v[60:63], v[108:111], v[128:131]
    v_and_b32 v48, v44, v24
    v_and_b32 v49, v44, v25
    v_and_b32 v50, v44, v26
    v_and_b32 v51, v44, v27
    s_waitcnt vmcnt(3)
    s_nop 0
    v_mfma_f32_16x16x32_bf16 v[128:131], v[48:51], v[112:115], v[128:131]
    v_and_b32 v52, v45, v24
    v_and_b32 v53, v45, v25
    v_and_b32 v54, v45, v26
    v_and_b32 v55, v45, v27
    s_waitcnt vmcnt(2)
    s_nop 0
    v_mfma_f32_16x16x32_bf16 v[128:131], v[52:55], v[116:119], v[128:131]
    v_and_b32 v56, v46, v24
    v_and_b32 v57, v46, v25
    v_and_b32 v58, v46, v26
    v_and_b32 v59, v46, v27
    s_waitcnt vmcnt(1)
    s_nop 0
    v_mfma_f32_16x16x32_bf16 v[128:131], v[56:59], v[120:123], v[128:131]
    v_and_b32 v60, v47, v24
    v_and_b32 v61, v47, v25
    v_and_b32 v62, v47, v26
    v_and_b32 v63, v47, v27
    s_waitcnt vmcnt(0)
    s_nop 0
    v_mfma_f32_16x16x32_bf16 v[128:131], v[60:63], v[124:127], v[128:131]
    s_nop 7
    v_bfi_b32 v128, v7, s46, v128
    v_bfi_b32 v129, v7, s47, v129
    v_bfi_b32 v130, v7, s48, v130
    v_bfi_b32 v131, v7, s64, v131
    s_cmp_eq_u32 s28, 0
    s_cbranch_scc1 L_A0
    s_mov_b64 exec, s[66:67]
    buffer_store_dwordx4 v[128:131], v30, s[36:39], s53 offen
    s_mov_b64 exec, -1
    s_and_b32 s33, s30, 3
    s_bitcmp1_b32 5, s33
    s_cbranch_scc1 L_down1
    s_branch L_fw
    s_endpgm
L_A0:
    buffer_store_dwordx4 v[128:131], v30, s[36:39], s53 offen
    s_lshr_b32 s33, s32, 2
    s_lshl_b32 s34, s31, 1
    s_add_u32 s33, s33, s34
    s_lshl_b32 s33, s33, 12
    s_add_u32 s33, s33, 4096
    v_lshlrev_b32 v4, 4, v0
    s_lshr_b32 s60, s30, 4
    s_bfe_u32 s61, s30, 0x10003
    s_and_b32 s59, s30, 7
    s_lshl_b32 s34, s61, 9
    s_lshl_b32 s35, s29, 6
    s_add_u32 s34, s34, s35
    s_lshl3_add_u32 s34, s59, s34
    s_lshl2_add_u32 s34, s60, s34
    v_and_b32 v50, 1, v1
    v_lshlrev_b32 v50, 1, v50
    v_lshrrev_b32 v51, 1, v1
    v_add3_u32 v50, v50, v51, s34
    v_lshlrev_b32 v50, 1, v50
    global_load_ushort v52, v50, s[4:5]
    v_and_b32 v53, 31, v0
    v_lshlrev_b32 v53, 3, v53
    v_lshrrev_b32 v54, 5, v0
    v_lshl_add_u32 v53, v54, 1, v53
    s_mov_b32 s57, 0
    s_movk_i32 s65, 0x3f0
    v_mov_b32 v6, 0
    s_sleep 4
L_qpoll:
    s_add_u32 s57, s57, 1
    s_cmp_gt_u32 s57, 100000
    s_cbranch_scc1 L_qdone
    s_cmp_eq_u32 s57, 6
    s_cbranch_scc1 L_qrs
L_qnors:
    buffer_load_dwordx4 v[8:11], v4, s[36:39], s33 offen offset:0 sc1
    buffer_load_dwordx4 v[12:15], v4, s[36:39], s33 offen offset:1024 sc1
    buffer_load_dwordx4 v[16:19], v4, s[36:39], s33 offen offset:2048 sc1
    buffer_load_dwordx4 v[20:23], v4, s[36:39], s33 offen offset:3072 sc1
    s_waitcnt vmcnt(0)
    v_xor_b32 v8, s46, v8
    v_xor_b32 v9, s47, v9
    v_xor_b32 v10, s48, v10
    v_xor_b32 v11, s64, v11
    v_xor_b32 v12, s46, v12
    v_xor_b32 v13, s47, v13
    v_xor_b32 v14, s48, v14
    v_xor_b32 v15, s64, v15
    v_xor_b32 v16, s46, v16
    v_xor_b32 v17, s47, v17
    v_xor_b32 v18, s48, v18
    v_xor_b32 v19, s64, v19
    v_xor_b32 v20, s46, v20
    v_xor_b32 v21, s47, v21
    v_xor_b32 v22, s48, v22
    v_xor_b32 v23, s64, v23
    v_or3_b32 v5, v8, v9, v10
    v_or3_b32 v6, v11, v15, v19
    v_or3_b32 v5, v5, v12, v13
    v_or_b32 v6, v6, v23
    v_or3_b32 v5, v5, v14, v16
    v_or3_b32 v5, v5, v17, v18
    v_or3_b32 v5, v5, v20, v21
    v_or_b32 v5, v5, v22
    v_and_or_b32 v5, v6, s65, v5
    v_and_b32 v5, v7, v5
    v_cmp_ne_u32 vcc, 0, v5
    s_and_b64 exec, exec, vcc
    s_cbranch_execnz L_qpoll
L_qdone:
    s_mov_b64 exec, -1
    v_and_b32 v6, 15, v6
    v_cmp_ne_u32 vcc, 0, v6
    s_cbranch_vccnz L_het
L_hetr:
    v_add_f32 v8, v8, v12
    v_add_f32 v16, v16, v20
    v_add_f32 v9, v9, v13
    v_add_f32 v17, v17, v21
    v_add_f32 v10, v10, v14
    v_add_f32 v18, v18, v22
    v_add_f32 v11, v11, v15
    v_add_f32 v19, v19, v23
    v_add_f32 v8, v8, v16
    v_add_f32 v9, v9, v17
    v_add_f32 v10, v10, v18
    v_add_f32 v11, v11, v19
    v_permlane32_swap_b32 v8, v9
    s_nop 0
    v_permlane32_swap_b32 v10, v11
    v_add_f32 v8, v8, v9
    v_add_f32 v10, v10, v11
    v_cvt_pk_bf16_f32 v8, v8, v10
    ds_write_b16 v53, v8
    ds_write_b16_d16_hi v53, v8 offset:4
    v_mov_b32 v5, 0
    ds_write_b32 v5, v7 offset:256
    v_lshrrev_b32 v32, 3, v0
    v_lshlrev_b32 v32, 13, v32
    v_and_b32 v33, 7, v0
    v_lshl_add_u32 v32, v33, 9, v32
    s_lshl_b32 s68, s29, 15
    s_add_u32 s68, s68, 4096
    s_mov_b32 exec_hi, 0
    buffer_load_dwordx4 v[36:39], v32, s[36:39], s68 offen sc1
    s_mov_b32 exec_hi, -1
    v_lshlrev_b32 v4, 10, v0
    v_lshl_add_u32 v33, v1, 3, v33
    v_lshlrev_b32 v33, 9, v33
    s_lshr_b32 s33, s29, 1
    s_lshl_b32 s33, s33, 15
    s_and_b32 s34, s29, 1
    s_lshl1_add_u32 s35, s60, s61
    s_lshl1_add_u32 s34, s35, s34
    s_lshl3_add_u32 s34, s34, s59
    s_lshl4_add_u32 s33, s34, s33
    s_add_u32 s33, s33, 491520
    s_lshl_b32 s35, s29, 14
    s_lshl4_add_u32 s35, s30, s35
    s_add_u32 s35, s35, 622592
    s_mov_b32 s70, 0x00ff00ff
    s_mov_b32 s71, 0x00ff00ff
    v_mov_b32 v24, 0
    v_mov_b32 v25, 0
    v_mov_b32 v26, 0
    v_mov_b32 v27, 0
    s_mov_b32 s57, 0
    v_lshlrev_b32 v52, 16, v52
    s_mov_b32 s62, 0x00010001
    s_mov_b32 s63, 0x00010001
    s_lshr_b32 s34, s32, 2
    s_lshl1_add_u32 s34, s31, s34
    s_lshl_b32 s34, s34, 7
    s_add_u32 s34, s34, 1048576
    s_and_b32 s58, s32, 3
    s_lshl4_add_u32 s34, s58, s34
    s_lshl3_add_u32 s65, s31, s32
    s_lshl_b32 s65, s65, 9
    s_add_u32 s65, s65, 917504
    v_and_b32 v12, 3, v0
    v_lshlrev_b32 v12, 3, v12
    v_mov_b32 v15, 1
    v_lshlrev_b32 v13, 4, v0
    s_mov_b32 s69, 0
    s_mov_b32 exec_hi, 0
L_stw:
    s_add_u32 s57, s57, 1
    s_cmp_gt_u32 s57, 100000
    s_cbranch_scc1 L_stwx
    s_sleep 2
    ds_read_b32 v8, v5 offset:268
    ds_read_b64 v[10:11], v12 offset:320
    s_waitcnt lgkmcnt(0)
    v_cmp_gt_u32 vcc, 4, v8
    s_cbranch_vccnz L_stw
L_stwx:
    v_max_f32_dpp v16, v10, v10 quad_perm:[1,0,3,2] row_mask:0xf bank_mask:0xf
    s_nop 1
    v_max_f32_dpp v16, v16, v16 quad_perm:[2,3,0,1] row_mask:0xf bank_mask:0xf
    v_sub_f32 v14, v10, v16
    v_mul_f32 v14, 0x3fb8aa3b, v14
    v_exp_f32 v14, v14
    s_nop 0
    v_mul_f32 v17, v11, v14
    s_nop 1
    v_add_f32_dpp v17, v17, v17 quad_perm:[1,0,3,2] row_mask:0xf bank_mask:0xf
    s_nop 1
    v_add_f32_dpp v17, v17, v17 quad_perm:[2,3,0,1] row_mask:0xf bank_mask:0xf
    v_mov_b32 v18, v16
    v_mov_b32 v19, v17
    v_mov_b32 v20, v16
    v_bfi_b32 v16, v7, s46, v16
    v_bfi_b32 v17, v7, s47, v17
    v_bfi_b32 v18, v7, s48, v18
    v_bfi_b32 v19, v7, s49, v19
    s_waitcnt vmcnt(0)
L_hchk:
    v_xor_b32 v36, s46, v36
    v_xor_b32 v37, s47, v37
    v_xor_b32 v38, s48, v38
    v_xor_b32 v39, s64, v39
    v_or3_b32 v36, v36, v37, v38
    v_or_b32 v36, v36, v39
    v_and_b32 v36, v7, v36
    v_cmp_ne_u32 vcc, 0, v36
    s_cbranch_vccnz L_het2
    ds_write_b32 v5, v15 offset:284
L_het2r:
    s_mov_b32 exec_lo, 1
    s_cmp_gt_u32 s69, 1
    s_cbranch_scc1 L_stt
    buffer_store_dwordx4 v[16:19], off, s[36:39], s34
L_sttr:
    s_mov_b32 exec_lo, -1
    s_and_b32 s34, s34, -64
    v_lshlrev_b32 v21, 1, v12
L_sd:
    s_add_u32 s57, s57, 1
    s_cmp_gt_u32 s57, 100000
    s_cbranch_scc1 L_sdx
    s_sleep 2
    ds_read_b32 v8, v5 offset:356
    s_waitcnt lgkmcnt(0)
    v_cmp_gt_u32 vcc, 1, v8
    s_cbranch_vccnz L_sd
L_sdx:
    s_setprio 3
L_sp:
    s_add_u32 s57, s57, 1
    s_cmp_gt_u32 s57, 100000
    s_cbranch_scc1 L_spx
    buffer_load_dwordx4 v[16:19], v21, s[36:39], s34 offen sc1
    s_waitcnt vmcnt(0)
    v_xor_b32 v16, s46, v16
    v_xor_b32 v17, s47, v17
    v_xor_b32 v18, s48, v18
    v_xor_b32 v19, s49, v19
    v_or3_b32 v6, v16, v17, v18
    v_or_b32 v6, v6, v19
    v_and_b32 v6, v7, v6
    v_cmp_ne_u32 vcc, 0, v6
    s_cbranch_vccnz L_sp
L_spx:
    v_max_f32_dpp v18, v16, v16 quad_perm:[1,0,3,2] row_mask:0xf bank_mask:0xf
    s_nop 1
    v_max_f32_dpp v18, v18, v18 quad_perm:[2,3,0,1] row_mask:0xf bank_mask:0xf
    v_sub_f32 v16, v16, v18
    v_sub_f32 v20, v20, v18
    v_mul_f32 v16, 0x3fb8aa3b, v16
    v_mul_f32 v20, 0x3fb8aa3b, v20
    v_exp_f32 v16, v16
    v_exp_f32 v20, v20
    v_mul_f32 v17, v17, v16
    s_nop 1
    v_add_f32_dpp v17, v17, v17 quad_perm:[1,0,3,2] row_mask:0xf bank_mask:0xf
    s_nop 1
    v_add_f32_dpp v17, v17, v17 quad_perm:[2,3,0,1] row_mask:0xf bank_mask:0xf
    v_rcp_f32 v17, v17
    s_nop 0
    v_mul_f32 v20, v20, v17
    v_mul_f32 v14, v14, v20
    ds_write_b64 v12, v[14:15] offset:288
L_ow1:
    s_add_u32 s57, s57, 1
    s_cmp_gt_u32 s57, 100000
    s_cbranch_scc1 L_ow1x
    s_sleep 2
    ds_read_b32 v8, v5 offset:276
    s_waitcnt lgkmcnt(0)
    v_cmp_gt_u32 vcc, 1, v8
    s_cbranch_vccnz L_ow1
L_ow1x:
L_ow:
    s_add_u32 s57, s57, 1
    s_cmp_gt_u32 s57, 100000
    s_cbranch_scc1 L_owx
    ds_read_b32 v8, v5 offset:276
    ds_read_b128 v[56:59], v13 offset:5376
    ds_read_b128 v[60:63], v13 offset:5888
    ds_read_b128 v[64:67], v13 offset:6400
    ds_read_b128 v[68:71], v13 offset:6912
    s_waitcnt lgkmcnt(4)
    v_cmp_gt_u32 vcc, 4, v8
    s_cbranch_vccnz L_ow
L_owx:
    s_waitcnt lgkmcnt(2)
    v_pk_add_f32 v[56:57], v[56:57], v[60:61]
    v_pk_add_f32 v[58:59], v[58:59], v[62:63]
    s_waitcnt lgkmcnt(0)
    v_pk_add_f32 v[64:65], v[64:65], v[68:69]
    v_pk_add_f32 v[66:67], v[66:67], v[70:71]
    v_pk_add_f32 v[56:57], v[56:57], v[64:65]
    v_pk_add_f32 v[58:59], v[58:59], v[66:67]
    v_bfi_b32 v56, v7, s46, v56
    v_bfi_b32 v57, v7, s47, v57
    v_bfi_b32 v58, v7, s48, v58
    v_bfi_b32 v59, v7, s49, v59
    buffer_store_dwordx4 v[56:59], v13, s[36:39], s65 offen sc1
    s_mov_b64 exec, -1
    s_mov_b32 s66, -1
    s_mov_b32 s67, 0
L_ywait:
    s_add_u32 s57, s57, 1
    s_cmp_gt_u32 s57, 100000
    s_cbranch_scc1 L_ywaitx
    s_sleep 1
    ds_read_b32 v8, v5 offset:280
    s_waitcnt lgkmcnt(0)
    v_cmp_gt_u32 vcc, 8, v8
    s_cbranch_vccnz L_ywait
L_ywaitx:
    s_mov_b64 exec, s[66:67]
    buffer_load_dwordx4 v[24:27], v4, s[36:39], s33 offen sc1
    s_mov_b64 exec, -1
L_swait:
    s_add_u32 s57, s57, 1
    s_cmp_gt_u32 s57, 100000
    s_cbranch_scc1 L_swaitx
    ds_read_b32 v8, v5 offset:272
    s_waitcnt lgkmcnt(0)
    v_cmp_gt_u32 vcc, 1, v8
    s_cbranch_vccnz L_swait
L_swaitx:
    s_mov_b64 exec, s[70:71]
    buffer_load_dwordx4 v[8:11], v33, s[36:39], s35 offen sc1
    s_mov_b64 exec, s[66:67]
    s_waitcnt vmcnt(1)
    s_branch L_ychk
L_ypoll:
    s_add_u32 s57, s57, 1
    s_cmp_gt_u32 s57, 100000
    s_cbranch_scc1 L_ydone
    buffer_load_dwordx4 v[24:27], v4, s[36:39], s33 offen sc1
    s_waitcnt vmcnt(0)
L_ychk:
    v_xor_b32 v24, s46, v24
    v_xor_b32 v25, s47, v25
    v_xor_b32 v26, s48, v26
    v_xor_b32 v27, s49, v27
    v_or3_b32 v6, v24, v25, v26
    v_or_b32 v6, v6, v27
    v_and_b32 v6, v7, v6
    v_cmp_ne_u32 vcc, 0, v6
    s_and_b64 exec, exec, vcc
    s_cbranch_execnz L_ypoll
L_ydone:
    s_mov_b64 exec, -1
    s_nop 1
    v_permlane32_swap_b32 v24, v25
    v_permlane32_swap_b32 v26, v27
    v_add_f32 v24, v24, v25
    v_add_f32 v26, v26, v27
    s_nop 1
    v_permlane16_swap_b32 v24, v26
    v_add_f32 v24, v24, v26
    s_nop 1
    v_add_f32_dpp v24, v24, v24 quad_perm:[1,0,3,2] row_mask:0xf bank_mask:0xf
    s_nop 1
    v_add_f32_dpp v24, v24, v24 quad_perm:[2,3,0,1] row_mask:0xf bank_mask:0xf
    s_nop 1
    v_add_f32_dpp v24, v24, v24 row_ror:4 row_mask:0xf bank_mask:0xf
    s_nop 1
    v_add_f32_dpp v24, v24, v24 row_ror:8 row_mask:0xf bank_mask:0xf
    v_cvt_pk_bf16_f32 v24, v24, v24
    v_and_b32 v24, 0xffff0000, v24
    v_mul_f32 v29, 0xbfb8aa3b, v24
    v_exp_f32 v29, v29
    s_nop 0
    v_add_f32 v29, 1.0, v29
    v_rcp_f32 v29, v29
    s_nop 0
    v_mul_f32 v28, v24, v29
    v_cvt_pk_bf16_f32 v28, v28, v28
    v_and_b32 v28, 0xffff0000, v28
    s_mov_b64 exec, s[70:71]
    s_branch L_zwt
L_zpoll:
    s_add_u32 s57, s57, 1
    s_cmp_gt_u32 s57, 100000
    s_cbranch_scc1 L_zdone
    buffer_load_dwordx4 v[8:11], v33, s[36:39], s35 offen sc1
L_zwt:
    s_waitcnt vmcnt(0)
    v_xor_b32 v8, s46, v8
    v_xor_b32 v9, s47, v9
    v_xor_b32 v10, s48, v10
    v_xor_b32 v11, s49, v11
    v_or3_b32 v6, v8, v9, v10
    v_or_b32 v6, v6, v11
    v_and_b32 v6, v7, v6
    v_cmp_ne_u32 vcc, 0, v6
    s_and_b64 exec, exec, vcc
    s_cbranch_execnz L_zpoll
L_zdone:
    s_mov_b64 exec, -1
    v_permlane32_swap_b32 v8, v9
    v_permlane32_swap_b32 v10, v11
    v_add_f32 v8, v8, v9
    v_add_f32 v10, v10, v11
    s_nop 1
    v_permlane16_swap_b32 v8, v10
    v_add_f32 v8, v8, v10
    s_nop 1
    v_add_f32_dpp v8, v8, v8 quad_perm:[1,0,3,2] row_mask:0xf bank_mask:0xf
    s_nop 1
    v_add_f32_dpp v8, v8, v8 quad_perm:[2,3,0,1] row_mask:0xf bank_mask:0xf
    s_nop 1
    v_add_f32_dpp v8, v8, v8 row_half_mirror row_mask:0xf bank_mask:0xf
    v_cvt_pk_bf16_f32 v8, v8, v8
    v_and_b32 v8, 0xffff0000, v8
    v_mul_f32 v8, v8, v28
    v_cvt_pk_bf16_f32 v8, v8, v8
    v_and_b32 v8, 0xffff0000, v8
    v_add_f32 v8, v8, v52
    v_cvt_pk_bf16_f32 v8, v8, v8
    s_mov_b64 exec, s[62:63]
    global_store_short v50, v8, s[22:23]
    s_cmp_eq_u32 s2, 0
    s_cbranch_scc0 L_A0x
    s_mov_b64 exec, 1
    v_mov_b32 v8, s44
    v_mov_b32 v9, s45
    buffer_store_dwordx2 v[8:9], v5, s[36:39], 0 offen
L_A0x:
L_Aexit:
    s_endpgm
L_S:
    s_add_u32 s98, s8, s33
    s_addc_u32 s99, s9, 0
    s_xor_b32 s34, s33, 4096
    s_add_u32 s100, s8, s34
    s_addc_u32 s101, s9, 0
    s_xor_b32 s34, s33, 8192
    s_add_u32 s40, s8, s34
    s_addc_u32 s41, s9, 0
    s_xor_b32 s34, s33, 12288
    s_add_u32 s42, s8, s34
    s_addc_u32 s43, s9, 0
    s_mov_b32 s36, s26
    s_mov_b32 s37, s27
    v_lshlrev_b32 v6, 4, v0
    s_mov_b32 s50, s30
    s_mov_b32 s51, s28
    s_lshl_b32 s65, s50, 8
    s_add_u32 s65, s65, 1048576
    s_lshl_b32 s66, s50, 12
    s_lshl_b32 s34, s51, 7
    s_add_u32 s66, s66, s34
    s_add_u32 s66, s66, 917504
    s_lshl_b32 s34, s28, 7
    s_lshl_b32 s69, s29, 5
    s_add_u32 s69, s69, s30
    s_lshl_b32 s69, s69, 9
    s_add_u32 s69, s69, 622592
    s_add_u32 s33, s34, s69
    s_mov_b64 exec, 1
    buffer_load_dword v31, off, s[36:39], s33 nt
    s_mov_b64 exec, -1
    s_lshl2_add_u32 s33, s50, s51
    s_lshl_b32 s33, s33, 15
    s_lshl_b32 s34, s29, 7
    s_add_u32 s33, s33, s34
    s_add_u32 s33, s33, 4096
    s_add_u32 s62, s12, s33
    s_addc_u32 s63, s13, 0
    v_and_b32 v7, 1, v1
    v_lshlrev_b32 v7, 1, v7
    v_lshrrev_b32 v12, 1, v1
    v_add_u32 v7, v7, v12
    v_and_b32 v12, 8, v0
    v_lshl_add_u32 v7, v12, 1, v7
    v_and_b32 v28, 7, v0
    v_lshlrev_b32 v7, 10, v7
    v_lshl_add_u32 v7, v28, 4, v7
    v_lshlrev_b32 v29, 11, v3
    v_lshl_add_u32 v29, v1, 9, v29
    v_lshl_add_u32 v29, v5, 4, v29
    v_lshl_add_u32 v29, v12, 3, v29
    v_lshl_add_u32 v28, v1, 3, v28
    v_lshlrev_b32 v28, 4, v28
    v_and_b32 v12, 1, v0
    v_lshlrev_b32 v12, 4, v12
    v_mov_b32 v13, 0xffff
    v_lshlrev_b32 v12, v12, v13
    v_and_b32 v13, 10, v0
    v_cmp_eq_u32 s[88:89], 0, v13
    v_cmp_eq_u32 s[90:91], 2, v13
    v_cmp_eq_u32 s[92:93], 8, v13
    v_cmp_eq_u32 s[94:95], 10, v13
    v_cndmask_b32 v8, 0, v12, s[88:89]
    v_cndmask_b32 v9, 0, v12, s[90:91]
    v_cndmask_b32 v10, 0, v12, s[92:93]
    v_cndmask_b32 v11, 0, v12, s[94:95]
    v_mov_b32 v12, 0x3ff
    v_lshlrev_b32 v13, 6, v1
    v_lshl_add_u32 v13, v5, 4, v13
    v_mov_b32 v15, 0
    s_waitcnt lgkmcnt(0)
    s_add_u32 s44, s44, 0x00100401
    s_add_u32 s45, s45, 1
    s_and_b32 s46, s44, 0x3ff
    s_bfe_u32 s47, s44, 0xa000a
    s_bfe_u32 s48, s44, 0xa0014
    s_and_b32 s49, s45, 0x3ff
    v_lshrrev_b32 v30, 5, v0
    v_lshlrev_b32 v30, 4, v30
    v_lshl_add_u32 v30, v2, 5, v30
    s_lshl_b32 s33, s28, 9
    v_add_u32 v26, s33, v30
    s_lshl_b32 s33, s28, 3
    v_mov_b32 v27, s33
    v_cmp_eq_u32 s[88:89], 0, v14
    v_cmp_eq_u32 s[90:91], 1, v14
    v_cmp_eq_u32 s[92:93], 2, v14
    v_cmp_eq_u32 s[94:95], 3, v14
    v_mov_b32 v14, 1
    v_lshl_add_u32 v2, v3, 3, v1
    v_lshlrev_b32 v2, 4, v2
    s_lshl3_add_u32 s67, s31, s32
    s_lshl_b32 s67, s67, 9
    s_add_u32 s67, s67, 917504
    s_lshl_b32 s33, s28, 7
    s_add_u32 s33, s33, s67
    s_mov_b64 exec, 1
    buffer_load_dword v31, off, s[36:39], s33
    s_mov_b64 exec, -1
    v_mov_b32 v3, v13
    v_add_u32 v13, 0x2000, v7
    s_mov_b32 s35, 0
    s_mov_b32 s68, 0
    s_mov_b32 s70, 0x00ff00ff
    s_mov_b32 s71, 0x00ff00ff
    s_waitcnt vmcnt(5)
    global_load_dwordx4 v[56:59], v4, s[56:57] offset:2048 nt
    s_waitcnt vmcnt(5)
    global_load_dwordx4 v[60:63], v4, s[56:57] offset:3072 nt
    s_waitcnt vmcnt(6)
    global_load_dwordx4 v[64:67], v4, s[58:59] offset:0 nt
    s_waitcnt vmcnt(6)
    global_load_dwordx4 v[68:71], v4, s[58:59] offset:1024 nt
    s_waitcnt vmcnt(6)
    global_load_dwordx4 v[72:75], v4, s[58:59] offset:2048 nt
    s_waitcnt vmcnt(4)
    global_load_dwordx4 v[76:79], v4, s[58:59] offset:3072 nt
    s_waitcnt vmcnt(4)
    global_load_dwordx4 v[80:83], v4, s[60:61] offset:0 nt
    s_waitcnt vmcnt(4)
    global_load_dwordx4 v[84:87], v4, s[60:61] offset:1024 nt
    s_waitcnt vmcnt(4)
    global_load_dwordx4 v[88:91], v4, s[60:61] offset:2048 nt
    s_waitcnt vmcnt(4)
    global_load_dwordx4 v[92:95], v4, s[60:61] offset:3072 nt
    s_waitcnt vmcnt(4)
    global_load_dwordx4 v[96:99], v6, s[98:99] offset:0 nt
    s_waitcnt vmcnt(4)
    global_load_dwordx4 v[100:103], v6, s[98:99] offset:1024 nt
    s_waitcnt vmcnt(4)
    global_load_dwordx4 v[104:107], v6, s[98:99] offset:2048 nt
    s_waitcnt vmcnt(4)
    global_load_dwordx4 v[108:111], v6, s[98:99] offset:3072 nt
    s_waitcnt vmcnt(4)
    global_load_dwordx4 v[112:115], v6, s[100:101] offset:0 nt
    ds_read_b64 v[16:17], v15 offset:256
    ds_read_b128 v[20:23], v3
    s_waitcnt vmcnt(5)
    global_load_dwordx4 v[116:119], v6, s[100:101] offset:1024 nt
    s_waitcnt lgkmcnt(0)
    v_min_u32 v17, v16, v17
    v_cmp_eq_u32 vcc, 0, v17
    s_cbranch_vccz L_qks
L_r0:
    s_waitcnt vmcnt(5)
    global_load_dwordx4 v[120:123], v6, s[100:101] offset:2048 nt
    s_cmp_eq_u32 s68, -1
    s_cbranch_scc1 L_i1
    ds_read_b64 v[16:17], v15 offset:256
    ds_read_b128 v[20:23], v3
    s_mov_b32 s68, 1
L_i1:
    s_waitcnt vmcnt(5)
    global_load_dwordx4 v[124:127], v6, s[100:101] offset:3072 nt
    s_cmp_eq_u32 s68, -1
    s_cbranch_scc1 L_r1
    s_waitcnt lgkmcnt(0)
    v_min_u32 v17, v16, v17
    v_cmp_eq_u32 vcc, 0, v17
    s_cbranch_vccz L_qks
L_r1:
    s_waitcnt vmcnt(5)
    global_load_dwordx4 v[128:131], v6, s[40:41] offset:0 nt
    s_cmp_eq_u32 s68, -1
    s_cbranch_scc1 L_i2
    ds_read_b64 v[16:17], v15 offset:256
    ds_read_b128 v[20:23], v3
    s_mov_b32 s68, 2
L_i2:
    s_waitcnt vmcnt(5)
    global_load_dwordx4 v[132:135], v6, s[40:41] offset:1024 nt
    s_cmp_eq_u32 s68, -1
    s_cbranch_scc1 L_r2
    s_waitcnt lgkmcnt(0)
    v_min_u32 v17, v16, v17
    v_cmp_eq_u32 vcc, 0, v17
    s_cbranch_vccz L_qks
L_r2:
    s_waitcnt vmcnt(5)
    global_load_dwordx4 v[136:139], v6, s[40:41] offset:2048 nt
    s_cmp_eq_u32 s68, -1
    s_cbranch_scc1 L_i3
    ds_read_b64 v[16:17], v15 offset:256
    ds_read_b128 v[20:23], v3
    s_mov_b32 s68, 3
L_i3:
    s_waitcnt vmcnt(5)
    global_load_dwordx4 v[140:143], v6, s[40:41] offset:3072 nt
    s_cmp_eq_u32 s68, -1
    s_cbranch_scc1 L_r3
    s_waitcnt lgkmcnt(0)
    v_min_u32 v17, v16, v17
    v_cmp_eq_u32 vcc, 0, v17
    s_cbranch_vccz L_qks
L_r3:
    ds_write_b32 v15, v14 offset:356
    s_waitcnt vmcnt(5)
    global_load_dwordx4 v[144:147], v6, s[42:43] offset:0 nt
    s_cmp_eq_u32 s68, -1
    s_cbranch_scc1 L_i4
    ds_read_b64 v[16:17], v15 offset:256
    ds_read_b128 v[20:23], v3
    s_mov_b32 s68, 4
L_i4:
    s_waitcnt vmcnt(5)
    global_load_dwordx4 v[148:151], v6, s[42:43] offset:1024 nt
    s_cmp_eq_u32 s68, -1
    s_cbranch_scc1 L_r4
    s_waitcnt lgkmcnt(0)
    v_min_u32 v17, v16, v17
    v_cmp_eq_u32 vcc, 0, v17
    s_cbranch_vccz L_qks
L_r4:
    s_waitcnt vmcnt(5)
    global_load_dwordx4 v[152:155], v6, s[42:43] offset:2048 nt
    s_waitcnt vmcnt(5)
    global_load_dwordx4 v[156:159], v6, s[42:43] offset:3072 nt
    s_mov_b64 exec, 1
    ds_add_u32 v15, v14 offset:280
    s_mov_b64 exec, -1
    s_cmp_eq_u32 s68, -1
    s_cbranch_scc1 L_pv
L_qlate:
    s_mov_b32 s68, 5
L_qwait:
    s_add_u32 s35, s35, 1
    s_cmp_gt_u32 s35, 100000
    s_cbranch_scc1 L_qks
    ds_read_b64 v[16:17], v15 offset:256
    ds_read_b128 v[20:23], v3
    s_waitcnt lgkmcnt(0)
    v_min_u32 v17, v16, v17
    v_cmp_eq_u32 vcc, 0, v17
    s_cbranch_vccnz L_qwait
L_qks:
    v_or_b32 v4, v8, v10
    v_or_b32 v5, v9, v11
    v_cndmask_b32 v176, 0, v20, s[88:89]
    v_cndmask_b32 v177, 0, v21, s[88:89]
    v_cndmask_b32 v178, 0, v22, s[88:89]
    v_cndmask_b32 v179, 0, v23, s[88:89]
    v_cndmask_b32 v180, 0, v20, s[90:91]
    v_cndmask_b32 v181, 0, v21, s[90:91]
    v_cndmask_b32 v182, 0, v22, s[90:91]
    v_cndmask_b32 v183, 0, v23, s[90:91]
    v_cndmask_b32 v184, 0, v20, s[92:93]
    v_cndmask_b32 v185, 0, v21, s[92:93]
    v_cndmask_b32 v186, 0, v22, s[92:93]
    v_cndmask_b32 v187, 0, v23, s[92:93]
    v_cndmask_b32 v188, 0, v20, s[94:95]
    v_cndmask_b32 v189, 0, v21, s[94:95]
    v_cndmask_b32 v190, 0, v22, s[94:95]
    v_cndmask_b32 v191, 0, v23, s[94:95]
    s_lshl_b32 s33, s28, 10
    v_add_u32 v31, s33, v6
    v_mfma_f32_16x16x32_bf16 v[192:195], v[32:35], v[176:179], 0
    v_mfma_f32_16x16x32_bf16 v[196:199], v[48:51], v[176:179], 0
    v_mfma_f32_16x16x32_bf16 v[200:203], v[64:67], v[176:179], 0
    v_mfma_f32_16x16x32_bf16 v[204:207], v[80:83], v[176:179], 0
    v_mfma_f32_16x16x32_bf16 v[192:195], v[36:39], v[180:183], v[192:195]
    v_mfma_f32_16x16x32_bf16 v[196:199], v[52:55], v[180:183], v[196:199]
    v_mfma_f32_16x16x32_bf16 v[200:203], v[68:71], v[180:183], v[200:203]
    v_mfma_f32_16x16x32_bf16 v[204:207], v[84:87], v[180:183], v[204:207]
    v_mfma_f32_16x16x32_bf16 v[192:195], v[40:43], v[184:187], v[192:195]
    v_mfma_f32_16x16x32_bf16 v[196:199], v[56:59], v[184:187], v[196:199]
    v_mfma_f32_16x16x32_bf16 v[200:203], v[72:75], v[184:187], v[200:203]
    v_mfma_f32_16x16x32_bf16 v[204:207], v[88:91], v[184:187], v[204:207]
    v_mfma_f32_16x16x32_bf16 v[192:195], v[44:47], v[188:191], v[192:195]
    v_mfma_f32_16x16x32_bf16 v[196:199], v[60:63], v[188:191], v[196:199]
    v_mfma_f32_16x16x32_bf16 v[200:203], v[76:79], v[188:191], v[200:203]
    v_mfma_f32_16x16x32_bf16 v[204:207], v[92:95], v[188:191], v[204:207]
    s_nop 4
    v_mov_b32_dpp v16, v192 quad_perm:[0,0,0,0] row_mask:0xf bank_mask:0xf
    v_mov_b32_dpp v17, v196 quad_perm:[0,0,0,0] row_mask:0xf bank_mask:0xf
    v_mov_b32_dpp v18, v200 quad_perm:[0,0,0,0] row_mask:0xf bank_mask:0xf
    v_mov_b32_dpp v19, v204 quad_perm:[0,0,0,0] row_mask:0xf bank_mask:0xf
    v_add_f32_dpp v16, v193, v16 quad_perm:[1,1,1,1] row_mask:0xf bank_mask:0xf
    v_add_f32_dpp v17, v197, v17 quad_perm:[1,1,1,1] row_mask:0xf bank_mask:0xf
    v_add_f32_dpp v18, v201, v18 quad_perm:[1,1,1,1] row_mask:0xf bank_mask:0xf
    v_add_f32_dpp v19, v205, v19 quad_perm:[1,1,1,1] row_mask:0xf bank_mask:0xf
    v_add_f32_dpp v16, v194, v16 quad_perm:[2,2,2,2] row_mask:0xf bank_mask:0xf
    v_add_f32_dpp v17, v198, v17 quad_perm:[2,2,2,2] row_mask:0xf bank_mask:0xf
    v_add_f32_dpp v18, v202, v18 quad_perm:[2,2,2,2] row_mask:0xf bank_mask:0xf
    v_add_f32_dpp v19, v206, v19 quad_perm:[2,2,2,2] row_mask:0xf bank_mask:0xf
    v_add_f32_dpp v16, v195, v16 quad_perm:[3,3,3,3] row_mask:0xf bank_mask:0xf
    v_add_f32_dpp v17, v199, v17 quad_perm:[3,3,3,3] row_mask:0xf bank_mask:0xf
    v_add_f32_dpp v18, v203, v18 quad_perm:[3,3,3,3] row_mask:0xf bank_mask:0xf
    v_add_f32_dpp v19, v207, v19 quad_perm:[3,3,3,3] row_mask:0xf bank_mask:0xf
    v_cvt_pk_bf16_f32 v20, v16, v17
    v_cvt_pk_bf16_f32 v21, v18, v19
    v_lshlrev_b32 v16, 16, v20
    v_and_b32 v17, 0xffff0000, v20
    v_lshlrev_b32 v18, 16, v21
    v_and_b32 v19, 0xffff0000, v21
    v_mul_f32 v16, 0x3db504f3, v16
    v_mul_f32 v17, 0x3db504f3, v17
    v_mul_f32 v18, 0x3db504f3, v18
    v_mul_f32 v19, 0x3db504f3, v19
    v_cvt_pk_bf16_f32 v20, v16, v17
    v_cvt_pk_bf16_f32 v21, v18, v19
    v_lshlrev_b32 v16, 16, v20
    v_and_b32 v17, 0xffff0000, v20
    v_lshlrev_b32 v18, 16, v21
    v_and_b32 v19, 0xffff0000, v21
    v_max3_f32 v24, v16, v17, v18
    v_max_f32 v24, v24, v19
    s_nop 1
    v_max_f32_dpp v24, v24, v24 row_ror:4 row_mask:0xf bank_mask:0xf
    s_nop 1
    v_max_f32_dpp v24, v24, v24 row_ror:8 row_mask:0xf bank_mask:0xf
    v_mov_b32 v25, v24
    s_nop 1
    v_permlane16_swap_b32 v24, v25
    v_max_f32 v24, v24, v25
    v_mov_b32 v25, v24
    s_nop 1
    v_permlane32_swap_b32 v24, v25
    v_max_f32 v24, v24, v25
    v_sub_f32 v16, v16, v24
    v_sub_f32 v17, v17, v24
    v_sub_f32 v18, v18, v24
    v_sub_f32 v19, v19, v24
    v_mul_f32 v16, 0x3fb8aa3b, v16
    v_mul_f32 v17, 0x3fb8aa3b, v17
    v_mul_f32 v18, 0x3fb8aa3b, v18
    v_mul_f32 v19, 0x3fb8aa3b, v19
    v_exp_f32 v16, v16
    v_exp_f32 v17, v17
    v_exp_f32 v18, v18
    v_exp_f32 v19, v19
    v_add_f32 v25, v16, v17
    v_add_f32 v20, v18, v19
    v_cvt_pk_bf16_f32 v16, v16, v16
    v_cvt_pk_bf16_f32 v17, v17, v17
    v_cvt_pk_bf16_f32 v18, v18, v18
    v_cvt_pk_bf16_f32 v19, v19, v19
    v_add_f32 v25, v25, v20
    s_nop 1
    v_add_f32_dpp v25, v25, v25 row_ror:4 row_mask:0xf bank_mask:0xf
    s_nop 1
    v_add_f32_dpp v25, v25, v25 row_ror:8 row_mask:0xf bank_mask:0xf
    v_mov_b32 v20, v25
    s_nop 1
    v_permlane16_swap_b32 v25, v20
    v_add_f32 v25, v25, v20
    v_mov_b32 v20, v25
    s_nop 1
    v_permlane32_swap_b32 v25, v20
    v_add_f32 v25, v25, v20
    s_mov_b64 exec, 1
    ds_write_b64 v27, v[24:25] offset:320
    ds_add_u32 v15, v14 offset:268
    s_mov_b64 exec, -1
    s_mov_b32 s33, s68
    s_mov_b32 s68, -1
    s_cmp_eq_u32 s33, 0
    s_cbranch_scc1 L_r0
    s_cmp_eq_u32 s33, 1
    s_cbranch_scc1 L_r1
    s_cmp_eq_u32 s33, 2
    s_cbranch_scc1 L_r2
    s_cmp_eq_u32 s33, 3
    s_cbranch_scc1 L_r3
    s_cmp_eq_u32 s33, 4
    s_cbranch_scc1 L_r4
L_pv:
    s_mov_b32 s35, 0
    v_and_b32_dpp v176, v16, v8 row_newbcast:0 row_mask:0xf bank_mask:0xf
    v_and_b32_dpp v177, v16, v9 row_newbcast:0 row_mask:0xf bank_mask:0xf
    v_and_b32_dpp v178, v16, v10 row_newbcast:0 row_mask:0xf bank_mask:0xf
    v_and_b32_dpp v179, v16, v11 row_newbcast:0 row_mask:0xf bank_mask:0xf
    s_nop 1
    v_mfma_f32_16x16x32_bf16 v[20:23], v[176:179], v[96:99], 0
    v_and_b32_dpp v180, v16, v8 row_newbcast:4 row_mask:0xf bank_mask:0xf
    v_and_b32_dpp v181, v16, v9 row_newbcast:4 row_mask:0xf bank_mask:0xf
    v_and_b32_dpp v182, v16, v10 row_newbcast:4 row_mask:0xf bank_mask:0xf
    v_and_b32_dpp v183, v16, v11 row_newbcast:4 row_mask:0xf bank_mask:0xf
    s_nop 1
    v_mfma_f32_16x16x32_bf16 v[20:23], v[180:183], v[100:103], v[20:23]
    v_and_b32_dpp v184, v16, v8 row_newbcast:8 row_mask:0xf bank_mask:0xf
    v_and_b32_dpp v185, v16, v9 row_newbcast:8 row_mask:0xf bank_mask:0xf
    v_and_b32_dpp v186, v16, v10 row_newbcast:8 row_mask:0xf bank_mask:0xf
    v_and_b32_dpp v187, v16, v11 row_newbcast:8 row_mask:0xf bank_mask:0xf
    s_nop 1
    v_mfma_f32_16x16x32_bf16 v[20:23], v[184:187], v[104:107], v[20:23]
    v_and_b32_dpp v188, v16, v8 row_newbcast:12 row_mask:0xf bank_mask:0xf
    v_and_b32_dpp v189, v16, v9 row_newbcast:12 row_mask:0xf bank_mask:0xf
    v_and_b32_dpp v190, v16, v10 row_newbcast:12 row_mask:0xf bank_mask:0xf
    v_and_b32_dpp v191, v16, v11 row_newbcast:12 row_mask:0xf bank_mask:0xf
    s_nop 1
    v_mfma_f32_16x16x32_bf16 v[20:23], v[188:191], v[108:111], v[20:23]
    v_and_b32_dpp v176, v17, v8 row_newbcast:0 row_mask:0xf bank_mask:0xf
    v_and_b32_dpp v177, v17, v9 row_newbcast:0 row_mask:0xf bank_mask:0xf
    v_and_b32_dpp v178, v17, v10 row_newbcast:0 row_mask:0xf bank_mask:0xf
    v_and_b32_dpp v179, v17, v11 row_newbcast:0 row_mask:0xf bank_mask:0xf
    s_nop 1
    v_mfma_f32_16x16x32_bf16 v[20:23], v[176:179], v[112:115], v[20:23]
    v_and_b32_dpp v180, v17, v8 row_newbcast:4 row_mask:0xf bank_mask:0xf
    v_and_b32_dpp v181, v17, v9 row_newbcast:4 row_mask:0xf bank_mask:0xf
    v_and_b32_dpp v182, v17, v10 row_newbcast:4 row_mask:0xf bank_mask:0xf
    v_and_b32_dpp v183, v17, v11 row_newbcast:4 row_mask:0xf bank_mask:0xf
    s_nop 1
    v_mfma_f32_16x16x32_bf16 v[20:23], v[180:183], v[116:119], v[20:23]
    v_and_b32_dpp v184, v17, v8 row_newbcast:8 row_mask:0xf bank_mask:0xf
    v_and_b32_dpp v185, v17, v9 row_newbcast:8 row_mask:0xf bank_mask:0xf
    v_and_b32_dpp v186, v17, v10 row_newbcast:8 row_mask:0xf bank_mask:0xf
    v_and_b32_dpp v187, v17, v11 row_newbcast:8 row_mask:0xf bank_mask:0xf
    s_nop 1
    v_mfma_f32_16x16x32_bf16 v[20:23], v[184:187], v[120:123], v[20:23]
    v_and_b32_dpp v188, v17, v8 row_newbcast:12 row_mask:0xf bank_mask:0xf
    v_and_b32_dpp v189, v17, v9 row_newbcast:12 row_mask:0xf bank_mask:0xf
    v_and_b32_dpp v190, v17, v10 row_newbcast:12 row_mask:0xf bank_mask:0xf
    v_and_b32_dpp v191, v17, v11 row_newbcast:12 row_mask:0xf bank_mask:0xf
    s_nop 1
    v_mfma_f32_16x16x32_bf16 v[20:23], v[188:191], v[124:127], v[20:23]
    v_and_b32_dpp v176, v18, v8 row_newbcast:0 row_mask:0xf bank_mask:0xf
    v_and_b32_dpp v177, v18, v9 row_newbcast:0 row_mask:0xf bank_mask:0xf
    v_and_b32_dpp v178, v18, v10 row_newbcast:0 row_mask:0xf bank_mask:0xf
    v_and_b32_dpp v179, v18, v11 row_newbcast:0 row_mask:0xf bank_mask:0xf
    s_nop 1
    v_mfma_f32_16x16x32_bf16 v[20:23], v[176:179], v[128:131], v[20:23]
    v_and_b32_dpp v180, v18, v8 row_newbcast:4 row_mask:0xf bank_mask:0xf
    v_and_b32_dpp v181, v18, v9 row_newbcast:4 row_mask:0xf bank_mask:0xf
    v_and_b32_dpp v182, v18, v10 row_newbcast:4 row_mask:0xf bank_mask:0xf
    v_and_b32_dpp v183, v18, v11 row_newbcast:4 row_mask:0xf bank_mask:0xf
    s_nop 1
    v_mfma_f32_16x16x32_bf16 v[20:23], v[180:183], v[132:135], v[20:23]
    v_and_b32_dpp v184, v18, v8 row_newbcast:8 row_mask:0xf bank_mask:0xf
    v_and_b32_dpp v185, v18, v9 row_newbcast:8 row_mask:0xf bank_mask:0xf
    v_and_b32_dpp v186, v18, v10 row_newbcast:8 row_mask:0xf bank_mask:0xf
    v_and_b32_dpp v187, v18, v11 row_newbcast:8 row_mask:0xf bank_mask:0xf
    s_waitcnt vmcnt(5)
    s_nop 0
    v_mfma_f32_16x16x32_bf16 v[20:23], v[184:187], v[136:139], v[20:23]
    v_and_b32_dpp v188, v18, v8 row_newbcast:12 row_mask:0xf bank_mask:0xf
    v_and_b32_dpp v189, v18, v9 row_newbcast:12 row_mask:0xf bank_mask:0xf
    v_and_b32_dpp v190, v18, v10 row_newbcast:12 row_mask:0xf bank_mask:0xf
    v_and_b32_dpp v191, v18, v11 row_newbcast:12 row_mask:0xf bank_mask:0xf
    s_waitcnt vmcnt(4)
    s_nop 0
    v_mfma_f32_16x16x32_bf16 v[20:23], v[188:191], v[140:143], v[20:23]
    v_and_b32_dpp v176, v19, v8 row_newbcast:0 row_mask:0xf bank_mask:0xf
    v_and_b32_dpp v177, v19, v9 row_newbcast:0 row_mask:0xf bank_mask:0xf
    v_and_b32_dpp v178, v19, v10 row_newbcast:0 row_mask:0xf bank_mask:0xf
    v_and_b32_dpp v179, v19, v11 row_newbcast:0 row_mask:0xf bank_mask:0xf
    s_waitcnt vmcnt(3)
    s_nop 0
    v_mfma_f32_16x16x32_bf16 v[20:23], v[176:179], v[144:147], v[20:23]
    v_and_b32_dpp v180, v19, v8 row_newbcast:4 row_mask:0xf bank_mask:0xf
    v_and_b32_dpp v181, v19, v9 row_newbcast:4 row_mask:0xf bank_mask:0xf
    v_and_b32_dpp v182, v19, v10 row_newbcast:4 row_mask:0xf bank_mask:0xf
    v_and_b32_dpp v183, v19, v11 row_newbcast:4 row_mask:0xf bank_mask:0xf
    ds_read_b64 v[24:25], v27 offset:288
    s_waitcnt vmcnt(2)
    v_mfma_f32_16x16x32_bf16 v[20:23], v[180:183], v[148:151], v[20:23]
    v_and_b32_dpp v184, v19, v8 row_newbcast:8 row_mask:0xf bank_mask:0xf
    v_and_b32_dpp v185, v19, v9 row_newbcast:8 row_mask:0xf bank_mask:0xf
    v_and_b32_dpp v186, v19, v10 row_newbcast:8 row_mask:0xf bank_mask:0xf
    v_and_b32_dpp v187, v19, v11 row_newbcast:8 row_mask:0xf bank_mask:0xf
    s_waitcnt vmcnt(1)
    s_nop 0
    v_mfma_f32_16x16x32_bf16 v[20:23], v[184:187], v[152:155], v[20:23]
    v_and_b32_dpp v188, v19, v8 row_newbcast:12 row_mask:0xf bank_mask:0xf
    v_and_b32_dpp v189, v19, v9 row_newbcast:12 row_mask:0xf bank_mask:0xf
    v_and_b32_dpp v190, v19, v10 row_newbcast:12 row_mask:0xf bank_mask:0xf
    v_and_b32_dpp v191, v19, v11 row_newbcast:12 row_mask:0xf bank_mask:0xf
    s_waitcnt lgkmcnt(0)
    v_cmp_eq_u32 vcc, 0, v25
    s_cbranch_vccnz L_fslow
L_fok:
    s_waitcnt vmcnt(0)
    v_mfma_f32_16x16x32_bf16 v[20:23], v[188:191], v[156:159], v[20:23]
    global_load_dwordx4 v[160:163], v7, s[62:63] offset:-4096 nt
    global_load_dwordx4 v[164:167], v7, s[62:63] offset:0 nt
    global_load_dwordx4 v[168:171], v13, s[62:63] offset:-4096 nt
    global_load_dwordx4 v[172:175], v13, s[62:63] offset:0 nt
    s_nop 3
    v_pk_mul_f32 v[20:21], v[20:21], v[24:25] op_sel_hi:[1,0]
    v_pk_mul_f32 v[22:23], v[22:23], v[24:25] op_sel_hi:[1,0]
    ds_write_b128 v26, v[20:23] offset:5376
    s_mov_b64 exec, 1
    ds_add_u32 v15, v14 offset:276
    s_mov_b64 exec, -1
    s_waitcnt vmcnt(0)
    buffer_load_dwordx4 v[48:51], v29, s[36:39], s66 offen sc1
    ds_read_b32 v3, v15 offset:284
    v_swap_b32 v162, v164
    v_swap_b32 v163, v165
    v_swap_b32 v170, v172
    v_swap_b32 v171, v173
    s_waitcnt lgkmcnt(0)
    v_readfirstlane_b32 s64, v3
    s_branch L_owt
L_opoll:
    s_add_u32 s35, s35, 1
    s_cmp_gt_u32 s35, 100000
    s_cbranch_scc1 L_odone
    buffer_load_dwordx4 v[48:51], v29, s[36:39], s66 offen sc1
L_owt:
    s_waitcnt vmcnt(0)
L_ochk:
    v_xor_b32 v48, s46, v48
    v_xor_b32 v49, s47, v49
    v_xor_b32 v50, s48, v50
    v_xor_b32 v51, s49, v51
    v_or3_b32 v16, v48, v49, v50
    v_or_b32 v16, v16, v51
    v_and_b32 v16, v12, v16
    v_cmp_ne_u32 vcc, 0, v16
    s_and_b64 exec, exec, vcc
    s_cbranch_execnz L_opoll
L_odone:
    s_mov_b64 exec, 1
    ds_add_u32 v15, v14 offset:280
    s_mov_b64 exec, -1
    v_permlane32_swap_b32 v48, v49
    v_permlane32_swap_b32 v50, v51
    v_add_f32 v48, v48, v49
    v_add_f32 v50, v50, v51
    s_nop 1
    v_permlane16_swap_b32 v48, v50
    v_add_f32 v48, v48, v50
    v_cvt_pk_bf16_f32 v40, v48, v48
    s_nop 1
    v_and_b32_dpp v176, v40, v4 quad_perm:[0,0,0,0] row_mask:0xf bank_mask:0xf
    v_and_b32_dpp v177, v40, v5 quad_perm:[0,0,0,0] row_mask:0xf bank_mask:0xf
    v_and_b32_dpp v178, v40, v4 quad_perm:[1,1,1,1] row_mask:0xf bank_mask:0xf
    v_and_b32_dpp v179, v40, v5 quad_perm:[1,1,1,1] row_mask:0xf bank_mask:0xf
    v_and_b32_dpp v180, v40, v4 quad_perm:[2,2,2,2] row_mask:0xf bank_mask:0xf
    v_and_b32_dpp v181, v40, v5 quad_perm:[2,2,2,2] row_mask:0xf bank_mask:0xf
    v_and_b32_dpp v182, v40, v4 quad_perm:[3,3,3,3] row_mask:0xf bank_mask:0xf
    v_and_b32_dpp v183, v40, v5 quad_perm:[3,3,3,3] row_mask:0xf bank_mask:0xf
    v_mfma_f32_16x16x32_bf16 v[56:59], v[176:179], v[160:163], 0
    v_mfma_f32_16x16x32_bf16 v[60:63], v[176:179], v[164:167], 0
    v_mfma_f32_16x16x32_bf16 v[56:59], v[180:183], v[168:171], v[56:59]
    v_mfma_f32_16x16x32_bf16 v[60:63], v[180:183], v[172:175], v[60:63]
    s_nop 7
    v_permlane32_swap_b32 v56, v60
    v_permlane32_swap_b32 v57, v61
    v_permlane32_swap_b32 v58, v62
    v_permlane32_swap_b32 v59, v63
    v_add_f32_dpp v56, v60, v56 row_ror:8 row_mask:0xf bank_mask:0xf
    v_add_f32_dpp v57, v61, v57 row_ror:8 row_mask:0xf bank_mask:0xf
    v_add_f32_dpp v58, v62, v58 row_ror:8 row_mask:0xf bank_mask:0xf
    v_add_f32_dpp v59, v63, v59 row_ror:8 row_mask:0xf bank_mask:0xf
    ds_write_b128 v31, v[56:59] offset:512
    s_mov_b64 exec, 1
    ds_add_rtn_u32 v17, v15, v14 offset:272
    s_mov_b64 exec, s[70:71]
    ds_read_b128 v[40:43], v6 offset:512
    ds_read_b128 v[44:47], v6 offset:1536
    ds_read_b128 v[48:51], v6 offset:2560
    ds_read_b128 v[52:55], v6 offset:3584
    s_waitcnt lgkmcnt(4)
    v_readfirstlane_b32 s33, v17
    s_cmp_eq_u32 s33, 3
    s_cbranch_scc0 L_Sx
    s_cmp_eq_u32 s64, 1
    s_waitcnt lgkmcnt(2)
    v_pk_add_f32 v[40:41], v[40:41], v[44:45]
    v_pk_add_f32 v[42:43], v[42:43], v[46:47]
    s_waitcnt lgkmcnt(0)
    v_pk_add_f32 v[48:49], v[48:49], v[52:53]
    v_pk_add_f32 v[50:51], v[50:51], v[54:55]
    v_pk_add_f32 v[40:41], v[40:41], v[48:49]
    v_pk_add_f32 v[42:43], v[42:43], v[50:51]
    v_bfi_b32 v40, v12, s46, v40
    v_bfi_b32 v41, v12, s47, v41
    v_bfi_b32 v42, v12, s48, v42
    v_bfi_b32 v43, v12, s49, v43
    s_cbranch_scc0 L_st2
    buffer_store_dwordx4 v[40:43], v28, s[36:39], s69 offen
L_st2r:
L_Sx:
L_end:
    s_endpgm
L_fslow:
    s_add_u32 s35, s35, 1
    s_cmp_gt_u32 s35, 100000
    s_cbranch_scc1 L_fok
    ds_read_b64 v[24:25], v27 offset:288
    s_waitcnt lgkmcnt(0)
    v_cmp_eq_u32 vcc, 0, v25
    s_cbranch_vccnz L_fslow
    s_branch L_fok
L_stt:
    buffer_store_dwordx4 v[16:19], off, s[36:39], s34 sc1
    s_branch L_sttr
L_fw:
    v_mov_b32 v15, 0
    s_mov_b32 s57, 0
L_fw1:
    s_add_u32 s57, s57, 1
    s_cmp_gt_u32 s57, 100000
    s_cbranch_scc1 L_fw2
    s_sleep 8
    ds_read_b32 v8, v15 offset:284
    s_waitcnt lgkmcnt(0)
    v_cmp_eq_u32 vcc, 0, v8
    s_cbranch_vccnz L_fw1
    v_cmp_eq_u32 vcc, 1, v8
    s_cbranch_vccnz L_end
L_fw2:
    s_mov_b64 exec, s[66:67]
    buffer_store_dwordx4 v[128:131], v30, s[36:39], s53 offen sc1
    s_mov_b64 exec, -1
    s_endpgm
L_down:
L_down1:
    v_mov_b32 v61, v30
    s_mul_i32 s58, s29, 43
    s_add_u32 s58, s58, 4
    s_add_u32 s56, s58, 43
    s_lshr_b32 s58, s58, 3
    s_lshr_b32 s56, s56, 3
    s_sub_u32 s56, s56, s58
    s_lshl_b32 s56, s56, 1
    s_and_b32 s59, s65, 3
    s_bfe_u32 s61, s65, 0x10002
    s_cmp_eq_u32 s33, 2
    s_cselect_b32 s33, 2, 0
    s_add_u32 s61, s61, s33
    s_mul_i32 s33, s61, s56
    s_lshl3_add_u32 s60, s58, s33
    s_lshl_b32 s60, s60, 12
    s_lshl_b32 s34, s59, 8
    s_add_u32 s60, s60, s34
    s_mov_b64 s[40:41], s[20:21]
    s_lshl_b32 s34, s56, 10
    v_mul_u32_u24 v60, s34, v1
    v_lshl_add_u32 v60, v2, 4, v60
    v_and_b32 v8, 1, v0
    v_lshlrev_b32 v8, 4, v8
    v_mov_b32 v9, 0xffff
    v_lshlrev_b32 v8, v8, v9
    v_and_b32 v9, 10, v0
    v_cmp_eq_u32 s[88:89], 0, v9
    v_cmp_eq_u32 s[90:91], 2, v9
    v_cmp_eq_u32 s[92:93], 8, v9
    v_cmp_eq_u32 s[94:95], 10, v9
    v_cndmask_b32 v4, 0, v8, s[88:89]
    v_cndmask_b32 v5, 0, v8, s[90:91]
    v_cndmask_b32 v6, 0, v8, s[92:93]
    v_cndmask_b32 v7, 0, v8, s[94:95]
    v_mov_b32 v12, 0x3ff
    v_cmp_le_u32 vcc, s56, v0
    s_sub_u32 s34, 48, s56
    v_mov_b32 v9, s34
    v_cndmask_b32 v8, 0, v9, vcc
    v_add3_u32 v13, v0, v8, s33
    v_lshlrev_b32 v13, 4, v13
    v_lshlrev_b32 v14, 4, v0
    v_lshl_add_u32 v11, v3, 2, v1
    s_lshl_b32 s34, s56, 2
    v_mul_u32_u24 v11, s34, v11
    s_lshl_b32 s55, s59, 15
    s_lshl2_add_u32 s33, s29, s61
    s_lshl_b32 s33, s33, 10
    s_add_u32 s55, s55, s33
    s_add_u32 s55, s55, 491520
    s_mul_i32 s58, s29, 24576
    s_add_u32 s58, s58, 294912
    s_lshl_b32 s34, s56, 1
    s_bfm_b64 s[62:63], s34, 0
    s_mov_b32 s57, 0
    v_mov_b32 v15, 0
    s_mov_b32 s64, 0
    s_mov_b32 s33, s55
    buffer_load_dword v62, v14, s[36:39], s33 offen
L_dwait:
    s_add_u32 s57, s57, 1
    s_cmp_gt_u32 s57, 100000
    s_cbranch_scc1 L_hgo
    s_sleep 2
    ds_read_b32 v8, v15 offset:256
    s_waitcnt lgkmcnt(0)
    v_cmp_eq_u32 vcc, 0, v8
    s_cbranch_vccnz L_dwait
L_hgo:
    s_mov_b64 exec, s[62:63]
L_hpoll:
    s_add_u32 s57, s57, 1
    s_cmp_gt_u32 s57, 100000
    s_cbranch_scc1 L_hdone
    s_mov_b32 s33, s58
    buffer_load_dwordx4 v[144:147], v13, s[36:39], s33 offen offset:0 sc1
    buffer_load_dwordx4 v[148:151], v13, s[36:39], s33 offen offset:1536 sc1
    s_add_u32 s33, s33, 3072
    buffer_load_dwordx4 v[152:155], v13, s[36:39], s33 offen offset:0 sc1
    buffer_load_dwordx4 v[156:159], v13, s[36:39], s33 offen offset:1536 sc1
    s_add_u32 s33, s33, 3072
    buffer_load_dwordx4 v[160:163], v13, s[36:39], s33 offen offset:0 sc1
    buffer_load_dwordx4 v[164:167], v13, s[36:39], s33 offen offset:1536 sc1
    s_add_u32 s33, s33, 3072
    buffer_load_dwordx4 v[168:171], v13, s[36:39], s33 offen offset:0 sc1
    buffer_load_dwordx4 v[172:175], v13, s[36:39], s33 offen offset:1536 sc1
    s_add_u32 s33, s33, 3072
    buffer_load_dwordx4 v[176:179], v13, s[36:39], s33 offen offset:0 sc1
    buffer_load_dwordx4 v[180:183], v13, s[36:39], s33 offen offset:1536 sc1
    s_add_u32 s33, s33, 3072
    buffer_load_dwordx4 v[184:187], v13, s[36:39], s33 offen offset:0 sc1
    buffer_load_dwordx4 v[188:191], v13, s[36:39], s33 offen offset:1536 sc1
    s_add_u32 s33, s33, 3072
    buffer_load_dwordx4 v[192:195], v13, s[36:39], s33 offen offset:0 sc1
    buffer_load_dwordx4 v[196:199], v13, s[36:39], s33 offen offset:1536 sc1
    s_add_u32 s33, s33, 3072
    buffer_load_dwordx4 v[200:203], v13, s[36:39], s33 offen offset:0 sc1
    buffer_load_dwordx4 v[204:207], v13, s[36:39], s33 offen offset:1536 sc1
    s_waitcnt vmcnt(0)
L_hc:
    v_xor_b32 v144, s46, v144
    v_xor_b32 v145, s47, v145
    v_xor_b32 v146, s48, v146
    v_xor_b32 v147, s49, v147
    v_xor_b32 v148, s46, v148
    v_xor_b32 v149, s47, v149
    v_xor_b32 v150, s48, v150
    v_xor_b32 v151, s49, v151
    v_xor_b32 v152, s46, v152
    v_xor_b32 v153, s47, v153
    v_xor_b32 v154, s48, v154
    v_xor_b32 v155, s49, v155
    v_xor_b32 v156, s46, v156
    v_xor_b32 v157, s47, v157
    v_xor_b32 v158, s48, v158
    v_xor_b32 v159, s49, v159
    v_xor_b32 v160, s46, v160
    v_xor_b32 v161, s47, v161
    v_xor_b32 v162, s48, v162
    v_xor_b32 v163, s49, v163
    v_xor_b32 v164, s46, v164
    v_xor_b32 v165, s47, v165
    v_xor_b32 v166, s48, v166
    v_xor_b32 v167, s49, v167
    v_xor_b32 v168, s46, v168
    v_xor_b32 v169, s47, v169
    v_xor_b32 v170, s48, v170
    v_xor_b32 v171, s49, v171
    v_xor_b32 v172, s46, v172
    v_xor_b32 v173, s47, v173
    v_xor_b32 v174, s48, v174
    v_xor_b32 v175, s49, v175
    v_xor_b32 v176, s46, v176
    v_xor_b32 v177, s47, v177
    v_xor_b32 v178, s48, v178
    v_xor_b32 v179, s49, v179
    v_xor_b32 v180, s46, v180
    v_xor_b32 v181, s47, v181
    v_xor_b32 v182, s48, v182
    v_xor_b32 v183, s49, v183
    v_xor_b32 v184, s46, v184
    v_xor_b32 v185, s47, v185
    v_xor_b32 v186, s48, v186
    v_xor_b32 v187, s49, v187
    v_xor_b32 v188, s46, v188
    v_xor_b32 v189, s47, v189
    v_xor_b32 v190, s48, v190
    v_xor_b32 v191, s49, v191
    v_xor_b32 v192, s46, v192
    v_xor_b32 v193, s47, v193
    v_xor_b32 v194, s48, v194
    v_xor_b32 v195, s49, v195
    v_xor_b32 v196, s46, v196
    v_xor_b32 v197, s47, v197
    v_xor_b32 v198, s48, v198
    v_xor_b32 v199, s49, v199
    v_xor_b32 v200, s46, v200
    v_xor_b32 v201, s47, v201
    v_xor_b32 v202, s48, v202
    v_xor_b32 v203, s49, v203
    v_xor_b32 v204, s46, v204
    v_xor_b32 v205, s47, v205
    v_xor_b32 v206, s48, v206
    v_xor_b32 v207, s49, v207
    v_or3_b32 v9, v144, v145, v146
    v_or3_b32 v9, v9, v147, v148
    v_or3_b32 v9, v9, v149, v150
    v_or3_b32 v9, v9, v151, v152
    v_or3_b32 v9, v9, v153, v154
    v_or3_b32 v9, v9, v155, v156
    v_or3_b32 v9, v9, v157, v158
    v_or3_b32 v9, v9, v159, v160
    v_or3_b32 v9, v9, v161, v162
    v_or3_b32 v9, v9, v163, v164
    v_or3_b32 v9, v9, v165, v166
    v_or3_b32 v9, v9, v167, v168
    v_or3_b32 v9, v9, v169, v170
    v_or3_b32 v9, v9, v171, v172
    v_or3_b32 v9, v9, v173, v174
    v_or3_b32 v9, v9, v175, v176
    v_or3_b32 v9, v9, v177, v178
    v_or3_b32 v9, v9, v179, v180
    v_or3_b32 v9, v9, v181, v182
    v_or3_b32 v9, v9, v183, v184
    v_or3_b32 v9, v9, v185, v186
    v_or3_b32 v9, v9, v187, v188
    v_or3_b32 v9, v9, v189, v190
    v_or3_b32 v9, v9, v191, v192
    v_or3_b32 v9, v9, v193, v194
    v_or3_b32 v9, v9, v195, v196
    v_or3_b32 v9, v9, v197, v198
    v_or3_b32 v9, v9, v199, v200
    v_or3_b32 v9, v9, v201, v202
    v_or3_b32 v9, v9, v203, v204
    v_or3_b32 v9, v9, v205, v206
    v_or_b32 v9, v9, v207
    v_and_b32 v9, v12, v9
    v_cmp_ne_u32 vcc, 0, v9
    s_and_b64 exec, exec, vcc
    s_cbranch_execz L_hdone
    s_sleep 4
    ds_read_b32 v8, v15 offset:284
    s_waitcnt lgkmcnt(0)
    v_readfirstlane_b32 s33, v8
    s_or_b32 s33, s33, s64
    s_cmp_eq_u32 s33, 2
    s_cbranch_scc0 L_hpoll
    s_mov_b64 s[34:35], exec
    s_mov_b64 exec, s[66:67]
    buffer_store_dwordx4 v[128:131], v61, s[36:39], s53 offen sc1
    s_mov_b64 exec, -1
    s_mov_b64 exec, s[34:35]
    s_mov_b32 s64, 1
    s_branch L_hpoll
L_hdone:
    s_mov_b64 exec, s[62:63]
    v_pk_add_f32 v[144:145], v[144:145], v[148:149]
    v_pk_add_f32 v[146:147], v[146:147], v[150:151]
    v_pk_add_f32 v[152:153], v[152:153], v[156:157]
    v_pk_add_f32 v[154:155], v[154:155], v[158:159]
    v_pk_add_f32 v[160:161], v[160:161], v[164:165]
    v_pk_add_f32 v[162:163], v[162:163], v[166:167]
    v_pk_add_f32 v[168:169], v[168:169], v[172:173]
    v_pk_add_f32 v[170:171], v[170:171], v[174:175]
    v_pk_add_f32 v[144:145], v[144:145], v[152:153]
    v_pk_add_f32 v[146:147], v[146:147], v[154:155]
    v_pk_add_f32 v[160:161], v[160:161], v[168:169]
    v_pk_add_f32 v[162:163], v[162:163], v[170:171]
    v_pk_add_f32 v[144:145], v[144:145], v[160:161]
    v_pk_add_f32 v[146:147], v[146:147], v[162:163]
    v_pk_add_f32 v[176:177], v[176:177], v[180:181]
    v_pk_add_f32 v[178:179], v[178:179], v[182:183]
    v_pk_add_f32 v[184:185], v[184:185], v[188:189]
    v_pk_add_f32 v[186:187], v[186:187], v[190:191]
    v_pk_add_f32 v[192:193], v[192:193], v[196:197]
    v_pk_add_f32 v[194:195], v[194:195], v[198:199]
    v_pk_add_f32 v[200:201], v[200:201], v[204:205]
    v_pk_add_f32 v[202:203], v[202:203], v[206:207]
    v_pk_add_f32 v[176:177], v[176:177], v[184:185]
    v_pk_add_f32 v[178:179], v[178:179], v[186:187]
    v_pk_add_f32 v[192:193], v[192:193], v[200:201]
    v_pk_add_f32 v[194:195], v[194:195], v[202:203]
    v_pk_add_f32 v[176:177], v[176:177], v[192:193]
    v_pk_add_f32 v[178:179], v[178:179], v[194:195]
    v_cvt_pk_bf16_f32 v144, v144, v145
    v_cvt_pk_bf16_f32 v146, v146, v147
    v_and_b32 v145, 0xffff0000, v144
    v_lshlrev_b32 v144, 16, v144
    v_and_b32 v147, 0xffff0000, v146
    v_lshlrev_b32 v146, 16, v146
    v_cvt_pk_bf16_f32 v176, v176, v177
    v_cvt_pk_bf16_f32 v178, v178, v179
    v_and_b32 v177, 0xffff0000, v176
    v_lshlrev_b32 v176, 16, v176
    v_and_b32 v179, 0xffff0000, v178
    v_lshlrev_b32 v178, 16, v178
    s_mov_b32 s33, 0x3d372713
    v_mul_f32 v56, v144, v144
    v_mul_f32 v57, v145, v145
    v_mul_f32 v58, v146, v146
    v_mul_f32 v59, v147, v147
    v_fma_f32 v56, v56, s33, 1.0
    v_fma_f32 v57, v57, s33, 1.0
    v_fma_f32 v58, v58, s33, 1.0
    v_fma_f32 v59, v59, s33, 1.0
    v_mul_f32 v56, v56, v144
    v_mul_f32 v57, v57, v145
    v_mul_f32 v58, v58, v146
    v_mul_f32 v59, v59, v147
    v_mul_f32 v56, 0xc0135761, v56
    v_mul_f32 v57, 0xc0135761, v57
    v_mul_f32 v58, 0xc0135761, v58
    v_mul_f32 v59, 0xc0135761, v59
    v_exp_f32 v56, v56
    v_exp_f32 v57, v57
    v_exp_f32 v58, v58
    v_exp_f32 v59, v59
    v_add_f32 v56, 1.0, v56
    v_add_f32 v57, 1.0, v57
    v_add_f32 v58, 1.0, v58
    v_add_f32 v59, 1.0, v59
    v_rcp_f32 v56, v56
    v_rcp_f32 v57, v57
    v_rcp_f32 v58, v58
    v_rcp_f32 v59, v59
    v_mul_f32 v144, v144, v56
    v_mul_f32 v145, v145, v57
    v_mul_f32 v146, v146, v58
    v_mul_f32 v147, v147, v59
    v_cvt_pk_bf16_f32 v144, v144, v144
    v_cvt_pk_bf16_f32 v145, v145, v145
    v_cvt_pk_bf16_f32 v146, v146, v146
    v_cvt_pk_bf16_f32 v147, v147, v147
    v_and_b32 v144, 0xffff0000, v144
    v_and_b32 v145, 0xffff0000, v145
    v_and_b32 v146, 0xffff0000, v146
    v_and_b32 v147, 0xffff0000, v147
    v_mul_f32 v144, v144, v176
    v_mul_f32 v145, v145, v177
    v_mul_f32 v146, v146, v178
    v_mul_f32 v147, v147, v179
    v_cvt_pk_bf16_f32 v144, v144, v144
    v_cvt_pk_bf16_f32 v145, v145, v145
    v_cvt_pk_bf16_f32 v146, v146, v146
    v_cvt_pk_bf16_f32 v147, v147, v147
    ds_write_b128 v14, v[144:147] offset:4608
    s_mov_b64 exec, -1
    ds_read_b64 v[16:17], v11 offset:4608
    ds_read_b64 v[18:19], v11 offset:4616
    ds_read_b64 v[20:21], v11 offset:4624
    ds_read_b64 v[22:23], v11 offset:4632
    ds_read_b64 v[24:25], v11 offset:4640
    ds_read_b64 v[26:27], v11 offset:4648
L_dv:
    s_add_u32 s57, s57, 1
    s_cmp_gt_u32 s57, 100000
    s_cbranch_scc1 L_dvx
    ds_read_b32 v8, v15 offset:280
    s_waitcnt lgkmcnt(0)
    v_cmp_gt_u32 vcc, 4, v8
    s_cbranch_vccz L_dvx
    s_sleep 2
    s_branch L_dv
L_dvx:
    v_mov_b32 v56, v128
    v_mov_b32 v57, v129
    v_mov_b32 v58, v130
    v_mov_b32 v59, v131
    s_cmp_eq_u32 s56, 10
    s_cbranch_scc1 L_d20
    s_add_u32 s33, s60, 10240
    buffer_load_dwordx4 v[104:107], v60, s[40:43], s33 offen offset:0 nt
    buffer_load_dwordx4 v[108:111], v60, s[40:43], s33 offen offset:1024 nt
L_d20:
    buffer_load_dwordx4 v[64:67], v60, s[40:43], s60 offen offset:0 nt
    buffer_load_dwordx4 v[68:71], v60, s[40:43], s60 offen offset:1024 nt
    buffer_load_dwordx4 v[72:75], v60, s[40:43], s60 offen offset:2048 nt
    buffer_load_dwordx4 v[76:79], v60, s[40:43], s60 offen offset:3072 nt
    s_add_u32 s60, s60, 4096
    buffer_load_dwordx4 v[80:83], v60, s[40:43], s60 offen offset:0 nt
    buffer_load_dwordx4 v[84:87], v60, s[40:43], s60 offen offset:1024 nt
    buffer_load_dwordx4 v[88:91], v60, s[40:43], s60 offen offset:2048 nt
    buffer_load_dwordx4 v[92:95], v60, s[40:43], s60 offen offset:3072 nt
    s_add_u32 s60, s60, 4096
    buffer_load_dwordx4 v[96:99], v60, s[40:43], s60 offen offset:0 nt
    buffer_load_dwordx4 v[100:103], v60, s[40:43], s60 offen offset:1024 nt
    v_mov_b32 v8, 0
    v_mov_b32 v9, 0
    v_mov_b32 v10, 0
    v_mov_b32 v11, 0
    s_cmp_eq_u32 s56, 10
    s_cbranch_scc1 L_m20
    v_and_b32 v48, v26, v4
    v_and_b32 v49, v26, v5
    v_and_b32 v50, v26, v6
    v_and_b32 v51, v26, v7
    s_waitcnt vmcnt(11)
    s_nop 0
    v_mfma_f32_16x16x32_bf16 v[8:11], v[48:51], v[104:107], v[8:11]
    v_and_b32 v52, v27, v4
    v_and_b32 v53, v27, v5
    v_and_b32 v54, v27, v6
    v_and_b32 v55, v27, v7
    s_waitcnt vmcnt(10)
    s_nop 0
    v_mfma_f32_16x16x32_bf16 v[8:11], v[52:55], v[108:111], v[8:11]
L_m20:
    v_and_b32 v40, v16, v4
    v_and_b32 v41, v16, v5
    v_and_b32 v42, v16, v6
    v_and_b32 v43, v16, v7
    s_waitcnt vmcnt(9)
    s_nop 0
    v_mfma_f32_16x16x32_bf16 v[8:11], v[40:43], v[64:67], v[8:11]
    v_and_b32 v44, v17, v4
    v_and_b32 v45, v17, v5
    v_and_b32 v46, v17, v6
    v_and_b32 v47, v17, v7
    s_waitcnt vmcnt(8)
    s_nop 0
    v_mfma_f32_16x16x32_bf16 v[8:11], v[44:47], v[68:71], v[8:11]
    v_and_b32 v48, v18, v4
    v_and_b32 v49, v18, v5
    v_and_b32 v50, v18, v6
    v_and_b32 v51, v18, v7
    s_waitcnt vmcnt(7)
    s_nop 0
    v_mfma_f32_16x16x32_bf16 v[8:11], v[48:51], v[72:75], v[8:11]
    v_and_b32 v52, v19, v4
    v_and_b32 v53, v19, v5
    v_and_b32 v54, v19, v6
    v_and_b32 v55, v19, v7
    s_waitcnt vmcnt(6)
    s_nop 0
    v_mfma_f32_16x16x32_bf16 v[8:11], v[52:55], v[76:79], v[8:11]
    v_and_b32 v40, v20, v4
    v_and_b32 v41, v20, v5
    v_and_b32 v42, v20, v6
    v_and_b32 v43, v20, v7
    s_waitcnt vmcnt(5)
    s_nop 0
    v_mfma_f32_16x16x32_bf16 v[8:11], v[40:43], v[80:83], v[8:11]
    v_and_b32 v44, v21, v4
    v_and_b32 v45, v21, v5
    v_and_b32 v46, v21, v6
    v_and_b32 v47, v21, v7
    s_waitcnt vmcnt(4)
    s_nop 0
    v_mfma_f32_16x16x32_bf16 v[8:11], v[44:47], v[84:87], v[8:11]
    v_and_b32 v48, v22, v4
    v_and_b32 v49, v22, v5
    v_and_b32 v50, v22, v6
    v_and_b32 v51, v22, v7
    s_waitcnt vmcnt(3)
    s_nop 0
    v_mfma_f32_16x16x32_bf16 v[8:11], v[48:51], v[88:91], v[8:11]
    v_and_b32 v52, v23, v4
    v_and_b32 v53, v23, v5
    v_and_b32 v54, v23, v6
    v_and_b32 v55, v23, v7
    s_waitcnt vmcnt(2)
    s_nop 0
    v_mfma_f32_16x16x32_bf16 v[8:11], v[52:55], v[92:95], v[8:11]
    v_and_b32 v40, v24, v4
    v_and_b32 v41, v24, v5
    v_and_b32 v42, v24, v6
    v_and_b32 v43, v24, v7
    s_waitcnt vmcnt(1)
    s_nop 0
    v_mfma_f32_16x16x32_bf16 v[8:11], v[40:43], v[96:99], v[8:11]
    v_and_b32 v44, v25, v4
    v_and_b32 v45, v25, v5
    v_and_b32 v46, v25, v6
    v_and_b32 v47, v25, v7
    s_waitcnt vmcnt(0)
    s_nop 0
    v_mfma_f32_16x16x32_bf16 v[8:11], v[44:47], v[100:103], v[8:11]
    s_nop 7
    v_bfi_b32 v8, v12, s46, v8
    v_bfi_b32 v9, v12, s47, v9
    v_bfi_b32 v10, v12, s48, v10
    v_bfi_b32 v11, v12, s49, v11
    buffer_store_dwordx4 v[8:11], v14, s[36:39], s55 offen sc1
    v_mov_b32 v128, v56
    v_mov_b32 v129, v57
    v_mov_b32 v130, v58
    v_mov_b32 v131, v59
    v_mov_b32 v30, v61
    s_branch L_fw
L_qrs:
    s_mov_b64 s[96:97], exec
    s_mov_b64 exec, -1
    buffer_store_dwordx4 v[128:131], v30, s[36:39], s53 offen sc1
    s_mov_b64 exec, s[96:97]
    s_branch L_qnors
L_het:
    buffer_store_dwordx4 v[128:131], v30, s[36:39], s53 offen sc1
    v_and_b32 v11, -16, v11
    v_and_b32 v15, -16, v15
    v_and_b32 v19, -16, v19
    v_and_b32 v23, -16, v23
    s_nop 1
    s_branch L_hetr
L_st2:
    buffer_store_dwordx4 v[40:43], v28, s[36:39], s69 offen sc1
    s_nop 1
    s_branch L_st2r
L_het2:
    s_add_u32 s69, s69, 1
    s_cmp_gt_u32 s69, 1
    s_cbranch_scc1 L_het3
    buffer_load_dwordx4 v[36:39], v32, s[36:39], s68 offen sc1
    s_waitcnt vmcnt(0)
    s_branch L_hchk
L_het3:
    v_mov_b32 v36, 2
    ds_write_b32 v5, v36 offset:284
    s_branch L_het2r
    .fill 2048, 4, 0xBF800000
s_endpgm
.section .rodata,"a"
.p2align 6
.amdhsa_kernel recurrent_scan__sliding_block_cached__glu_gated_geglu__decode_kernel
  .amdhsa_next_free_vgpr 208
  .amdhsa_next_free_sgpr 102
  .amdhsa_accum_offset 208
  .amdhsa_group_segment_fixed_size 0
  .amdhsa_kernarg_size 96
  .amdhsa_user_sgpr_count 2
  .amdhsa_user_sgpr_kernarg_segment_ptr 1
  .amdhsa_system_sgpr_workgroup_id_x 1
  .amdhsa_float_denorm_mode_32 3
.end_amdhsa_kernel
```
